```python
import torch

def _softmax(x, axis=-1):
    return torch.softmax(x, dim=axis)
def _gelu(x):
    return torch.nn.functional.gelu(x, approximate="tanh")
def _silu(x):
    return torch.nn.functional.silu(x)
def _sigmoid(x):
    return torch.sigmoid(x)
def _layernorm(x, axis=-1, eps=1e-5):
    m = x.mean(dim=axis, keepdim=True)
    v = x.var(dim=axis, keepdim=True, unbiased=False)
    return (x - m) / torch.sqrt(v + eps)
def _scatter_add(tgt, idx, src, axis=0):
    return tgt.clone().index_add_(axis, idx, src)
def _segment_sum(src, seg, n):
    out = torch.zeros((n,) + src.shape[1:], dtype=src.dtype)
    return out.index_add_(0, seg, src)
def _pad(x, pw):
    flat = tuple(v for pair in reversed(pw) for v in pair)
    return torch.nn.functional.pad(x, flat)

kernel_name = 'standalone__self_sup_conv_stem_hubert__speech'

def setup_inputs():

    _w = (lambda a: (lambda t: t.to(torch.bfloat16) if t.is_floating_point() else t)(torch.as_tensor(a)))
    B, T, D, K = 2, 16000, 256, 15
    scale = (1.0 / (K * D)) ** 0.5
    return {
        "x": _w((lambda *s: torch.randn(*s, dtype=torch.bfloat16) * 0.05)(B, T, D)),
        "w": _w((lambda *s: torch.randn(*s, dtype=torch.bfloat16) * 0.05)(K, D, D) * scale),
        "b": _w((lambda *s: torch.randn(*s, dtype=torch.bfloat16) * 0.05)(D) * 0.1),
        "gamma": _w(torch.ones((D,), dtype=float)),
        "beta": _w(torch.zeros((D,), dtype=float)),
    }

def reference(x, w, b, gamma, beta):
    B, T, D = x.shape
    K = w.shape[0]
    s = 2
    L = (T - K) // s + 1
    y = torch.einsum('blc,cd->bld', x[:, 0 : s * L : s, :], w[0])
    for i in range(1, K):
        y = y + torch.einsum('blc,cd->bld', x[:, i : i + s * L : s, :], w[i])
    y = y + b[None, None, :]
    mu = y.mean(1, keepdims=True)
    var = ((y - mu) ** 2).mean(1, keepdims=True)
    yn = (y - mu) / torch.sqrt(var + 1e-5)
    yn = yn * gamma[None, None, :] + beta[None, None, :]
    return _gelu(yn)
```

```asm
; @launch grid=(256,1,1) block=(512,1,1) lds=158592
.amdgcn_target "amdgcn-amd-amdhsa--gfx950"
.text
.globl standalone__self_sup_conv_stem_hubert__speech_kernel
.p2align 8
.type standalone__self_sup_conv_stem_hubert__speech_kernel,@function
standalone__self_sup_conv_stem_hubert__speech_kernel:
  s_load_dwordx4 s[32:35], s[0:1], 0
  s_load_dwordx4 s[40:43], s[0:1], 40
  s_load_dwordx2 s[44:45], s[0:1], 56
  s_load_dwordx4 s[36:39], s[0:1], 24
  s_cmp_ge_u32 s2, 256
  s_cbranch_scc1 L_end
  v_readfirstlane_b32 s46, v0
  v_and_b32 v0, 63, v0
  s_and_b32 s47, s2, 7
  s_lshl_b32 s47, s47, 3
  s_lshr_b32 s55, s2, 5
  s_add_u32 s47, s47, s55
  s_bfe_u32 s48, s2, 0x20003
  s_lshr_b32 s49, s47, 5
  s_and_b32 s47, s47, 31
  s_mov_b32 s57, 0xffff0000
  s_cmp_lt_u32 s46, 256
  s_cbranch_scc1 L_compute
L_loader:
  s_bfe_u32 s46, s46, 0x20006
  s_memrealtime s[70:71]
  s_mul_i32 s61, s49, 8192000
  s_mul_i32 s55, s47, 256000
  s_add_u32 s61, s61, s55
  v_lshrrev_b32 v10, 3, v0
  v_and_b32 v11, 7, v0
  v_lshlrev_b32 v12, 4, v11
  v_lshl_add_u32 v1, v10, 11, v12
  s_lshl_b32 s75, s46, 16
  s_add_u32 s51, s61, s75
  s_mul_i32 s74, s46, 4224
  v_bfe_u32 v13, v0, 4, 1
  s_and_b32 s55, s46, 1
  s_lshl_b32 s55, s55, 1
  v_or_b32 v13, s55, v13
  v_lshlrev_b32 v13, 5, v13
  v_xor_b32 v13, v13, v12
  v_lshl_add_u32 v13, v10, 9, v13
  s_lshl_b32 s55, s48, 7
  s_lshl_b32 s73, s46, 12
  s_add_u32 s55, s55, s73
  v_add_u32 v3, s55, v13
  s_lshl_b32 s73, s46, 10
  s_mov_b32 s52, 0
  v_mov_b32 v9, 0
  s_lshl_b32 s55, s46, 4
  s_lshl_b32 s56, s48, 6
  s_add_u32 s55, s55, s56
  v_add_u32 v14, s55, v0
  v_lshlrev_b32 v15, 10, v14
  s_waitcnt lgkmcnt(0)
  s_mov_b32 s4, s32
  s_and_b32 s5, s33, 0xffff
  s_mov_b32 s6, 16384000
  s_mov_b32 s7, 0x20000
  s_mov_b32 s8, s34
  s_and_b32 s9, s35, 0xffff
  s_mov_b32 s10, 1966080
  s_mov_b32 s11, 0x20000
  s_cmp_lg_u32 s46, 0
  s_cbranch_scc1 L_nt1
  s_mov_b32 m0, 16896
  s_add_u32 s55, s51, 262144
  s_mov_b64 exec, 0xff
  buffer_load_dwordx4 v1, s[4:7], s55 offen lds
  s_mov_b64 exec, -1
  L_nt1:
  s_add_u32 m0, s74, 0
  s_add_u32 s55, s51, 0
  buffer_load_dwordx4 v1, s[4:7], s55 offen lds
  s_add_u32 m0, s74, 1056
  s_add_u32 s55, s51, 16384
  buffer_load_dwordx4 v1, s[4:7], s55 offen lds
  s_add_u32 m0, s74, 2112
  s_add_u32 s55, s51, 32768
  buffer_load_dwordx4 v1, s[4:7], s55 offen lds
  s_add_u32 m0, s74, 3168
  s_add_u32 s55, s51, 49152
  buffer_load_dwordx4 v1, s[4:7], s55 offen lds
  s_add_u32 m0, s74, 49792
  s_add_u32 s55, s51, 1024
  buffer_load_dwordx4 v1, s[4:7], s55 offen lds
  s_add_u32 m0, s74, 50848
  s_add_u32 s55, s51, 17408
  buffer_load_dwordx4 v1, s[4:7], s55 offen lds
  s_add_u32 m0, s74, 51904
  s_add_u32 s55, s51, 33792
  buffer_load_dwordx4 v1, s[4:7], s55 offen lds
  s_add_u32 m0, s74, 52960
  s_add_u32 s55, s51, 50176
  buffer_load_dwordx4 v1, s[4:7], s55 offen lds
  s_add_u32 m0, s73, 17024
  s_add_u32 s55, s52, 0
  buffer_load_dwordx4 v3, s[8:11], s55 offen lds
  s_add_u32 m0, s73, 21120
  s_add_u32 s55, s52, 524288
  buffer_load_dwordx4 v3, s[8:11], s55 offen lds
  s_add_u32 m0, s73, 25216
  s_add_u32 s55, s52, 1048576
  buffer_load_dwordx4 v3, s[8:11], s55 offen lds
  s_add_u32 m0, s73, 41600
  s_add_u32 s55, s52, 1572864
  buffer_load_dwordx4 v3, s[8:11], s55 offen lds
  s_add_u32 m0, s73, 29312
  s_add_u32 s55, s52, 16384
  buffer_load_dwordx4 v3, s[8:11], s55 offen lds
  s_add_u32 m0, s73, 33408
  s_add_u32 s55, s52, 540672
  buffer_load_dwordx4 v3, s[8:11], s55 offen lds
  s_add_u32 m0, s73, 37504
  s_add_u32 s55, s52, 1064960
  buffer_load_dwordx4 v3, s[8:11], s55 offen lds
  s_add_u32 m0, s73, 45696
  s_add_u32 s55, s52, 1589248
  buffer_load_dwordx4 v3, s[8:11], s55 offen lds
  s_mov_b32 s20, s42
  s_and_b32 s21, s43, 0xffff
  s_mov_b32 s22, 256
  s_mov_b32 s23, 0x20000
  buffer_load_dwordx2 v[64:65], v9, s[20:23], 0 offen sc0 sc1
  s_add_u32 m0, s73, 66816
  s_add_u32 s55, s52, 262144
  buffer_load_dwordx4 v3, s[8:11], s55 offen lds
  s_add_u32 m0, s73, 70912
  s_add_u32 s55, s52, 786432
  buffer_load_dwordx4 v3, s[8:11], s55 offen lds
  s_add_u32 m0, s73, 75008
  s_add_u32 s55, s52, 1310720
  buffer_load_dwordx4 v3, s[8:11], s55 offen lds
  s_add_u32 m0, s73, 91392
  s_add_u32 s55, s52, 1835008
  buffer_load_dwordx4 v3, s[8:11], s55 offen lds
  s_add_u32 m0, s73, 79104
  s_add_u32 s55, s52, 278528
  buffer_load_dwordx4 v3, s[8:11], s55 offen lds
  s_add_u32 m0, s73, 83200
  s_add_u32 s55, s52, 802816
  buffer_load_dwordx4 v3, s[8:11], s55 offen lds
  s_add_u32 m0, s73, 87296
  s_add_u32 s55, s52, 1327104
  buffer_load_dwordx4 v3, s[8:11], s55 offen lds
  s_add_u32 m0, s73, 95488
  s_add_u32 s55, s52, 1851392
  buffer_load_dwordx4 v3, s[8:11], s55 offen lds
  v_lshlrev_b32 v13, 4, v0
  v_add_u32 v4, s74, v13
  v_add_u32 v5, 99584, v4
  v_cmp_eq_u32 vcc, 7, v10
  v_add_u32 v6, 128, v4
  v_add_u32 v12, 160, v4
  v_cndmask_b32 v6, v6, v12, vcc
  v_lshlrev_b32 v8, 3, v0
  s_mov_b32 s16, s44
  s_and_b32 s17, s45, 0xffff
  s_mov_b32 s18, 1572864
  s_mov_b32 s19, 0x20000
  s_mul_i32 s55, s49, 4092416
  s_mul_i32 s56, s47, 128000
  s_add_u32 s55, s55, s56
  s_add_u32 s12, s40, s55
  s_addc_u32 s13, s41, 0
  s_and_b32 s13, s13, 0xffff
  s_cmp_eq_u32 s47, 31
  s_mov_b32 s14, 124416
  s_cselect_b32 s14, s14, 128000
  s_mov_b32 s15, 0x20000
  s_lshl_b32 s66, s49, 2
  s_add_u32 s66, s66, s48
  s_lshl_b32 s66, s66, 15
  s_lshl_b32 s55, s46, 8
  s_add_u32 s66, s66, s55
  s_mov_b32 s50, 32768
  s_mov_b32 s60, 0
  s_mov_b32 s53, 0
  s_lshl_b32 s67, s46, 9
  s_add_u32 s67, s67, 262144
  s_waitcnt vmcnt(9)
  s_barrier
  s_setprio 3
  ds_read_b128 v[16:19], v6 offset:0
  ds_read_b128 v[20:23], v6 offset:1056
  ds_read_b128 v[24:27], v6 offset:2112
  ds_read_b128 v[28:31], v6 offset:3168
  s_setprio 0
  s_waitcnt vmcnt(17)
  s_setprio 3
  ds_read_b128 v[32:35], v4 offset:49792
  ds_read_b128 v[36:39], v4 offset:50848
  ds_read_b128 v[40:43], v4 offset:51904
  ds_read_b128 v[44:47], v4 offset:52960
  s_setprio 0
  s_waitcnt lgkmcnt(0)
  s_cmp_lg_u32 s46, 0
  s_cbranch_scc1 L_nt2
  s_mov_b32 m0, 116480
  s_add_u32 s55, s51, 262656
  s_mov_b64 exec, 0xff
  buffer_load_dwordx4 v1, s[4:7], s55 offen lds
  s_mov_b64 exec, -1
  L_nt2:
  s_add_u32 m0, s74, 99584
  s_add_u32 s55, s51, 512
  buffer_load_dwordx4 v1, s[4:7], s55 offen lds
  v_lshlrev_b32 v48, 16, v32
  v_lshlrev_b32 v49, 16, v16
  v_and_b32 v50, s57, v32
  v_and_b32 v51, s57, v16
  v_lshlrev_b32 v52, 16, v33
  v_lshlrev_b32 v53, 16, v17
  v_and_b32 v54, s57, v33
  s_add_u32 m0, s74, 100640
  s_add_u32 s55, s51, 16896
  buffer_load_dwordx4 v1, s[4:7], s55 offen lds
  v_and_b32 v55, s57, v17
  v_sub_f32 v48, v48, v49
  v_sub_f32 v50, v50, v51
  v_sub_f32 v52, v52, v53
  v_sub_f32 v54, v54, v55
  v_cvt_pk_bf16_f32 v80, v48, v50
  v_cvt_pk_bf16_f32 v81, v52, v54
  s_add_u32 m0, s74, 101696
  s_add_u32 s55, s51, 33280
  buffer_load_dwordx4 v1, s[4:7], s55 offen lds
  v_lshlrev_b32 v48, 16, v34
  v_lshlrev_b32 v49, 16, v18
  v_and_b32 v50, s57, v34
  v_and_b32 v51, s57, v18
  v_lshlrev_b32 v52, 16, v35
  v_lshlrev_b32 v53, 16, v19
  v_and_b32 v54, s57, v35
  s_add_u32 m0, s74, 102752
  s_add_u32 s55, s51, 49664
  buffer_load_dwordx4 v1, s[4:7], s55 offen lds
  v_and_b32 v55, s57, v19
  v_sub_f32 v48, v48, v49
  v_sub_f32 v50, v50, v51
  v_sub_f32 v52, v52, v53
  v_sub_f32 v54, v54, v55
  v_cvt_pk_bf16_f32 v82, v48, v50
  v_cvt_pk_bf16_f32 v83, v52, v54
  s_add_u32 m0, s73, 116608
  s_add_u32 s55, s52, 131072
  buffer_load_dwordx4 v3, s[8:11], s55 offen lds
  v_lshlrev_b32 v48, 16, v36
  v_lshlrev_b32 v49, 16, v20
  v_and_b32 v50, s57, v36
  v_and_b32 v51, s57, v20
  v_lshlrev_b32 v52, 16, v37
  v_lshlrev_b32 v53, 16, v21
  v_and_b32 v54, s57, v37
  s_add_u32 m0, s73, 120704
  s_add_u32 s55, s52, 655360
  buffer_load_dwordx4 v3, s[8:11], s55 offen lds
  v_and_b32 v55, s57, v21
  v_sub_f32 v48, v48, v49
  v_sub_f32 v50, v50, v51
  v_sub_f32 v52, v52, v53
  v_sub_f32 v54, v54, v55
  v_cvt_pk_bf16_f32 v84, v48, v50
  v_cvt_pk_bf16_f32 v85, v52, v54
  s_add_u32 m0, s73, 124800
  s_add_u32 s55, s52, 1179648
  buffer_load_dwordx4 v3, s[8:11], s55 offen lds
  v_lshlrev_b32 v48, 16, v38
  v_lshlrev_b32 v49, 16, v22
  v_and_b32 v50, s57, v38
  v_and_b32 v51, s57, v22
  v_lshlrev_b32 v52, 16, v39
  v_lshlrev_b32 v53, 16, v23
  v_and_b32 v54, s57, v39
  s_add_u32 m0, s73, 141184
  s_add_u32 s55, s52, 1703936
  buffer_load_dwordx4 v3, s[8:11], s55 offen lds
  v_and_b32 v55, s57, v23
  v_sub_f32 v48, v48, v49
  v_sub_f32 v50, v50, v51
  v_sub_f32 v52, v52, v53
  v_sub_f32 v54, v54, v55
  v_cvt_pk_bf16_f32 v86, v48, v50
  v_cvt_pk_bf16_f32 v87, v52, v54
  s_waitcnt vmcnt(8)
  s_waitcnt lgkmcnt(0)
  v_add_u32 v6, 99584, v6
  s_barrier
  s_waitcnt vmcnt(16)
  s_mov_b32 s56, 16384
L_cn:
  v_readfirstlane_b32 s62, v64
  v_readfirstlane_b32 s63, v65
  s_sub_u32 s55, s70, s62
  s_cmp_lt_i32 s55, 1000
  s_cselect_b32 s55, s62, 0
  s_cmp_lt_u32 s56, 16128
  s_cselect_b32 s55, s62, s55
  s_cmp_lg_u32 s55, 0
  s_cbranch_scc1 L_cn_ok
  s_sub_u32 s56, s56, 1
  s_cbranch_scc1 L_cn_ok
  buffer_load_dwordx2 v[64:65], v9, s[20:23], 0 offen sc0 sc1
  s_waitcnt vmcnt(0)
  s_branch L_cn
L_cn_ok:
  s_bfe_u32 s55, s2, 0x20001
  s_lshl_b32 s55, s55, 5
  s_lshr_b32 s56, s2, 3
  s_add_u32 s55, s55, s56
  s_lshl_b32 s55, s55, 1
  s_and_b32 s56, s2, 1
  s_add_u32 s55, s55, s56
  s_lshl_b32 s55, s55, 3
  s_add_u32 s55, s55, 262144
  s_cmp_eq_u32 s46, 0
  s_cselect_b32 s55, s55, 1073741824
  s_mov_b64 exec, 1
  buffer_store_dwordx2 v[64:65], v9, s[16:19], s55 offen sc0 sc1
  v_mov_b32 v12, 157568
  ds_write_b64 v12, v[64:65]
  s_mov_b64 exec, -1
  s_add_u32 m0, s73, 128896
  s_add_u32 s55, s52, 147456
  buffer_load_dwordx4 v3, s[8:11], s55 offen lds
  v_lshlrev_b32 v48, 16, v40
  v_lshlrev_b32 v49, 16, v24
  v_and_b32 v50, s57, v40
  s_add_u32 m0, s73, 132992
  s_add_u32 s55, s52, 671744
  buffer_load_dwordx4 v3, s[8:11], s55 offen lds
  v_and_b32 v51, s57, v24
  v_lshlrev_b32 v52, 16, v41
  v_lshlrev_b32 v53, 16, v25
  v_and_b32 v54, s57, v41
  s_add_u32 m0, s73, 137088
  s_add_u32 s55, s52, 1196032
  buffer_load_dwordx4 v3, s[8:11], s55 offen lds
  v_and_b32 v55, s57, v25
  v_sub_f32 v48, v48, v49
  v_sub_f32 v50, v50, v51
  s_add_u32 m0, s73, 145280
  s_add_u32 s55, s52, 1720320
  buffer_load_dwordx4 v3, s[8:11], s55 offen lds
  v_sub_f32 v52, v52, v53
  v_sub_f32 v54, v54, v55
  v_cvt_pk_bf16_f32 v88, v48, v50
  v_cvt_pk_bf16_f32 v89, v52, v54
  s_add_u32 m0, s74, 0
  s_add_u32 s55, s51, 1536
  buffer_load_dwordx4 v1, s[4:7], s55 offen lds
  v_lshlrev_b32 v48, 16, v42
  v_lshlrev_b32 v49, 16, v26
  v_and_b32 v50, s57, v42
  s_add_u32 m0, s74, 1056
  s_add_u32 s55, s51, 17920
  buffer_load_dwordx4 v1, s[4:7], s55 offen lds
  v_and_b32 v51, s57, v26
  v_lshlrev_b32 v52, 16, v43
  v_lshlrev_b32 v53, 16, v27
  v_and_b32 v54, s57, v43
  s_add_u32 m0, s74, 2112
  s_add_u32 s55, s51, 34304
  buffer_load_dwordx4 v1, s[4:7], s55 offen lds
  v_and_b32 v55, s57, v27
  v_sub_f32 v48, v48, v49
  v_sub_f32 v50, v50, v51
  s_add_u32 m0, s74, 3168
  s_add_u32 s55, s51, 50688
  buffer_load_dwordx4 v1, s[4:7], s55 offen lds
  v_sub_f32 v52, v52, v53
  v_sub_f32 v54, v54, v55
  v_cvt_pk_bf16_f32 v90, v48, v50
  v_cvt_pk_bf16_f32 v91, v52, v54
  s_add_u32 m0, s73, 17024
  s_add_u32 s55, s52, 393216
  buffer_load_dwordx4 v3, s[8:11], s55 offen lds
  v_lshlrev_b32 v48, 16, v44
  v_lshlrev_b32 v49, 16, v28
  v_and_b32 v50, s57, v44
  s_add_u32 m0, s73, 21120
  s_add_u32 s55, s52, 917504
  buffer_load_dwordx4 v3, s[8:11], s55 offen lds
  v_and_b32 v51, s57, v28
  v_lshlrev_b32 v52, 16, v45
  v_lshlrev_b32 v53, 16, v29
  v_and_b32 v54, s57, v45
  s_add_u32 m0, s73, 25216
  s_add_u32 s55, s52, 1441792
  buffer_load_dwordx4 v3, s[8:11], s55 offen lds
  v_and_b32 v55, s57, v29
  v_sub_f32 v48, v48, v49
  v_sub_f32 v50, v50, v51
  s_add_u32 m0, s73, 29312
  s_add_u32 s55, s52, 409600
  buffer_load_dwordx4 v3, s[8:11], s55 offen lds
  v_sub_f32 v52, v52, v53
  v_sub_f32 v54, v54, v55
  v_cvt_pk_bf16_f32 v92, v48, v50
  v_cvt_pk_bf16_f32 v93, v52, v54
  s_add_u32 m0, s73, 33408
  s_add_u32 s55, s52, 933888
  buffer_load_dwordx4 v3, s[8:11], s55 offen lds
  v_lshlrev_b32 v48, 16, v46
  v_lshlrev_b32 v49, 16, v30
  v_and_b32 v50, s57, v46
  s_add_u32 m0, s73, 37504
  s_add_u32 s55, s52, 1458176
  buffer_load_dwordx4 v3, s[8:11], s55 offen lds
  v_and_b32 v51, s57, v30
  v_lshlrev_b32 v52, 16, v47
  v_lshlrev_b32 v53, 16, v31
  v_and_b32 v54, s57, v47
  s_add_u32 m0, s73, 41600
  s_add_u32 s55, s50, 1835008
  buffer_load_dwordx4 v3, s[8:11], s55 offen lds
  v_and_b32 v55, s57, v31
  v_sub_f32 v48, v48, v49
  v_sub_f32 v50, v50, v51
  s_add_u32 m0, s73, 45696
  s_add_u32 s55, s50, 1851392
  buffer_load_dwordx4 v3, s[8:11], s55 offen lds
  v_sub_f32 v52, v52, v53
  v_sub_f32 v54, v54, v55
  v_cvt_pk_bf16_f32 v94, v48, v50
  v_cvt_pk_bf16_f32 v95, v52, v54
  s_waitcnt vmcnt(12) lgkmcnt(0)
  s_barrier
  s_mov_b32 s58, 262144
  buffer_load_dwordx2 v[56:57], v8, s[16:19], s58 offen sc0 sc1
  ds_write_b128 v4, v[80:83] offset:49792
  ds_write_b128 v4, v[84:87] offset:50848
  ds_read_b128 v[16:19], v6 offset:0
  ds_read_b128 v[20:23], v6 offset:1056
  ds_read_b128 v[24:27], v6 offset:2112
  ds_read_b128 v[28:31], v6 offset:3168
  s_waitcnt vmcnt(0)
  s_mov_b32 s58, 262144
  s_mov_b32 s56, 16384
L_spin0:
  v_cmp_eq_u64 vcc, s[62:63], v[56:57]
  s_cmp_eq_u64 vcc, -1
  s_cbranch_scc1 L_spin0_ok
  s_sub_u32 s56, s56, 1
  s_cbranch_scc1 L_spin0_ok
  buffer_load_dwordx2 v[56:57], v8, s[16:19], s58 offen sc0 sc1
  s_waitcnt vmcnt(0)
  s_branch L_spin0
L_spin0_ok:
  s_add_u32 m0, s73, 66816
  s_add_u32 s55, s53, 524288
  buffer_load_dwordx4 v3, s[16:19], s55 offen sc1 lds
  s_add_u32 m0, s73, 70912
  s_add_u32 s55, s53, 655360
  buffer_load_dwordx4 v3, s[16:19], s55 offen sc1 lds
  s_add_u32 m0, s73, 75008
  s_add_u32 s55, s53, 786432
  buffer_load_dwordx4 v3, s[16:19], s55 offen sc1 lds
  s_add_u32 m0, s73, 91392
  s_add_u32 s55, s53, 917504
  buffer_load_dwordx4 v3, s[16:19], s55 offen sc1 lds
  s_add_u32 m0, s73, 79104
  s_add_u32 s55, s53, 540672
  buffer_load_dwordx4 v3, s[16:19], s55 offen sc1 lds
  s_add_u32 m0, s73, 83200
  s_add_u32 s55, s53, 671744
  buffer_load_dwordx4 v3, s[16:19], s55 offen sc1 lds
  s_add_u32 m0, s73, 87296
  s_add_u32 s55, s53, 802816
  buffer_load_dwordx4 v3, s[16:19], s55 offen sc1 lds
  s_add_u32 m0, s73, 95488
  s_add_u32 s55, s53, 933888
  buffer_load_dwordx4 v3, s[16:19], s55 offen sc1 lds
  s_add_u32 m0, s73, 149376
  s_add_u32 s55, s50, 1572864
  buffer_load_dwordx4 v3, s[8:11], s55 offen lds
  s_add_u32 m0, s73, 153472
  s_add_u32 s55, s50, 1589248
  buffer_load_dwordx4 v3, s[8:11], s55 offen lds
  s_add_u32 s55, s61, 128
  s_mov_b64 exec, 0xffff
  buffer_load_dword v66, v15, s[4:7], s55 offen
  s_mov_b64 exec, -1
  s_add_u32 s55, s61, 640
  s_mov_b64 exec, 0xffff
  buffer_load_dword v66, v15, s[4:7], s55 offen
  s_mov_b64 exec, -1
  s_waitcnt vmcnt(13) lgkmcnt(0)
  s_branch L_join
L_compute:
  s_lshr_b32 s46, s46, 6
  s_memrealtime s[62:63]
  v_lshrrev_b32 v232, 5, v0
  s_lshl_b32 s55, s46, 1
  v_add_u32 v232, s55, v232
  v_and_b32 v233, 31, v0
  v_lshlrev_b32 v233, 4, v233
  s_bfe_u32 s55, s2, 0x20001
  s_lshl_b32 s55, s55, 5
  s_lshr_b32 s56, s2, 3
  s_add_u32 s55, s55, s56
  s_lshl_b32 s55, s55, 1
  s_and_b32 s56, s2, 1
  s_add_u32 s55, s55, s56
  s_lshl_b32 s55, s55, 9
  v_add_u32 v233, s55, v233
  v_lshl_add_u32 v234, v232, 17, v233
  v_and_b32 v232, 3, v232
  v_lshl_add_u32 v233, v232, 19, v233
  s_lshr_b32 s52, s46, 1
  s_lshl_b32 s52, s52, 17
  s_add_u32 s50, s52, 262144
  s_waitcnt lgkmcnt(0)
  s_mov_b32 s8, s34
  s_and_b32 s9, s35, 0xffff
  s_mov_b32 s10, 1966080
  s_mov_b32 s11, 0x20000
  buffer_load_dwordx4 v[112:115], v233, s[8:11], s52 offen
  buffer_load_dwordx4 v[116:119], v233, s[8:11], s50 offen
  s_mov_b32 s20, s42
  s_and_b32 s21, s43, 0xffff
  s_mov_b32 s22, 256
  s_mov_b32 s23, 0x20000
  s_or_b32 s55, s2, s46
  s_cmp_lg_u32 s55, 0
  s_cbranch_scc1 L_nononce
  s_or_b32 s62, s62, 1
  v_mov_b32 v235, 0
  v_mov_b32 v238, s62
  v_mov_b32 v239, s63
  s_mov_b64 exec, 1
  buffer_store_dwordx2 v[238:239], v235, s[20:23], 0 offen sc0 sc1
  s_mov_b64 exec, -1
L_nononce:
  s_cmp_lg_u32 s46, 1
  s_cbranch_scc1 L_nocpf
  s_getpc_b64 s[74:75]
L_pc:
  s_lshr_b32 s55, s2, 3
  s_lshl_b32 s55, s55, 9
  s_add_u32 s74, s74, s55
  s_addc_u32 s75, s75, 0
  s_sub_u32 s74, s74, L_pc-standalone__self_sup_conv_stem_hubert__speech_kernel
  s_subb_u32 s75, s75, 0
  v_lshlrev_b32 v236, 7, v0
  s_mov_b64 exec, 15
  global_load_dword v237, v236, s[74:75]
  s_mov_b64 exec, -1
L_nocpf:
  s_mov_b32 s16, s44
  s_and_b32 s17, s45, 0xffff
  s_mov_b32 s18, 1572864
  s_mov_b32 s19, 0x20000
  s_mov_b32 s53, 524288
  s_mul_i32 s55, s49, 4092416
  s_mul_i32 s56, s47, 128000
  s_add_u32 s55, s55, s56
  s_add_u32 s12, s40, s55
  s_addc_u32 s13, s41, 0
  s_and_b32 s13, s13, 0xffff
  s_cmp_eq_u32 s47, 31
  s_mov_b32 s14, 124416
  s_cselect_b32 s14, s14, 128000
  s_mov_b32 s15, 0x20000
  s_mov_b32 s64, 0x7fff7fff
  s_cselect_b32 s64, s64, -1
  s_mov_b32 s65, s64
  s_lshl_b32 s66, s49, 2
  s_add_u32 s66, s66, s48
  s_lshl_b32 s66, s66, 15
  s_lshl_b32 s55, s46, 8
  s_add_u32 s66, s66, s55
  s_lshl_b32 s55, s47, 10
  s_add_u32 s66, s66, s55
  v_and_b32 v120, 15, v0
  v_lshrrev_b32 v121, 4, v0
  v_mul_u32_u24 v122, 1056, v120
  v_lshl_add_u32 v1, v121, 4, v122
  v_bfe_u32 v124, v0, 2, 2
  v_lshl_add_u32 v122, v121, 3, v124
  v_lshlrev_b32 v122, 7, v122
  v_lshrrev_b32 v124, 1, v124
  v_and_b32 v125, 1, v121
  v_lshl_or_b32 v124, v125, 1, v124
  v_xor_b32 v124, s46, v124
  v_lshl_add_u32 v122, v124, 5, v122
  v_and_b32 v124, 3, v0
  v_lshl_add_u32 v122, v124, 3, v122
  v_add_u32 v2, 17024, v122
  v_add_u32 v7, 41600, v122
  v_lshlrev_b32 v8, 1, v122
  v_add_u32 v8, 290560, v8
  v_add_u32 v3, 49792, v1
  v_add_u32 v5, 99584, v1
  v_add_u32 v4, 49792, v2
  v_add_u32 v6, 99584, v2
  v_lshrrev_b32 v122, 2, v120
  v_lshl_add_u32 v9, v121, 2, v122
  v_lshlrev_b32 v9, 4, v9
  s_lshl_b32 s55, s46, 2
  v_add_u32 v122, s55, v121
  v_lshrrev_b32 v124, 1, v122
  v_and_b32 v122, 1, v122
  v_lshl_or_b32 v122, v122, 3, v124
  v_and_b32 v124, 7, v120
  v_xor_b32 v122, v122, v124
  v_lshlrev_b32 v122, 4, v122
  v_lshl_add_u32 v10, v120, 12, v122
  v_xor_b32 v11, 0x80, v10
  v_lshrrev_b32 v248, 3, v0
  v_and_b32 v250, 7, v0
  s_lshl_b32 s55, s46, 5
  v_add_u32 v248, s55, v248
  v_bfe_u32 v244, v0, 4, 1
  v_lshl_or_b32 v244, v244, 3, v250
  s_lshl_b32 s55, s46, 1
  s_and_b32 s55, s55, 7
  v_xor_b32 v244, s55, v244
  v_lshlrev_b32 v244, 4, v244
  v_lshl_add_u32 v244, v248, 8, v244
  v_xor_b32 v245, 0x80, v244
  v_xor_b32 v246, 0x10, v244
  v_xor_b32 v247, 0x90, v244
  v_lshlrev_b32 v248, 9, v248
  v_lshl_add_u32 v248, v250, 4, v248
  s_lshl_b32 s55, s48, 7
  v_add_u32 v248, s55, v248
  v_add_u32 v249, 0x2000, v248
  v_lshlrev_b32 v250, 5, v250
  v_add_u32 v250, 157632, v250
  v_pk_mov_b32 v[16:17], 0, 0
  v_pk_mov_b32 v[18:19], 0, 0
  v_pk_mov_b32 v[20:21], 0, 0
  v_pk_mov_b32 v[22:23], 0, 0
  v_pk_mov_b32 v[24:25], 0, 0
  v_pk_mov_b32 v[26:27], 0, 0
  v_pk_mov_b32 v[28:29], 0, 0
  v_pk_mov_b32 v[30:31], 0, 0
  v_pk_mov_b32 v[32:33], 0, 0
  v_pk_mov_b32 v[34:35], 0, 0
  v_pk_mov_b32 v[36:37], 0, 0
  v_pk_mov_b32 v[38:39], 0, 0
  v_pk_mov_b32 v[40:41], 0, 0
  v_pk_mov_b32 v[42:43], 0, 0
  v_pk_mov_b32 v[44:45], 0, 0
  v_pk_mov_b32 v[46:47], 0, 0
  v_pk_mov_b32 v[48:49], 0, 0
  v_pk_mov_b32 v[50:51], 0, 0
  v_pk_mov_b32 v[52:53], 0, 0
  v_pk_mov_b32 v[54:55], 0, 0
  v_pk_mov_b32 v[56:57], 0, 0
  v_pk_mov_b32 v[58:59], 0, 0
  v_pk_mov_b32 v[60:61], 0, 0
  v_pk_mov_b32 v[62:63], 0, 0
  v_pk_mov_b32 v[64:65], 0, 0
  v_pk_mov_b32 v[66:67], 0, 0
  v_pk_mov_b32 v[68:69], 0, 0
  v_pk_mov_b32 v[70:71], 0, 0
  v_pk_mov_b32 v[72:73], 0, 0
  v_pk_mov_b32 v[74:75], 0, 0
  v_pk_mov_b32 v[76:77], 0, 0
  v_pk_mov_b32 v[78:79], 0, 0
  v_pk_mov_b32 v[80:81], 0, 0
  v_pk_mov_b32 v[82:83], 0, 0
  v_pk_mov_b32 v[84:85], 0, 0
  v_pk_mov_b32 v[86:87], 0, 0
  v_pk_mov_b32 v[88:89], 0, 0
  v_pk_mov_b32 v[90:91], 0, 0
  v_pk_mov_b32 v[92:93], 0, 0
  v_pk_mov_b32 v[94:95], 0, 0
  v_pk_mov_b32 v[96:97], 0, 0
  v_pk_mov_b32 v[98:99], 0, 0
  v_pk_mov_b32 v[100:101], 0, 0
  v_pk_mov_b32 v[102:103], 0, 0
  v_pk_mov_b32 v[104:105], 0, 0
  v_pk_mov_b32 v[106:107], 0, 0
  v_pk_mov_b32 v[108:109], 0, 0
  v_pk_mov_b32 v[110:111], 0, 0
  s_waitcnt vmcnt(0)
  v_lshlrev_b32 v224, 16, v112
  v_lshlrev_b32 v225, 16, v116
  v_and_b32 v226, s57, v112
  v_and_b32 v227, s57, v116
  v_lshlrev_b32 v228, 16, v113
  v_lshlrev_b32 v229, 16, v117
  v_and_b32 v230, s57, v113
  v_and_b32 v231, s57, v117
  v_sub_f32 v224, v224, v225
  v_sub_f32 v226, v226, v227
  v_sub_f32 v228, v228, v229
  v_sub_f32 v230, v230, v231
  v_cvt_pk_bf16_f32 v112, v224, v226
  v_cvt_pk_bf16_f32 v113, v228, v230
  v_lshlrev_b32 v224, 16, v114
  v_lshlrev_b32 v225, 16, v118
  v_and_b32 v226, s57, v114
  v_and_b32 v227, s57, v118
  v_lshlrev_b32 v228, 16, v115
  v_lshlrev_b32 v229, 16, v119
  v_and_b32 v230, s57, v115
  v_and_b32 v231, s57, v119
  v_sub_f32 v224, v224, v225
  v_sub_f32 v226, v226, v227
  v_sub_f32 v228, v228, v229
  v_sub_f32 v230, v230, v231
  v_cvt_pk_bf16_f32 v114, v224, v226
  v_cvt_pk_bf16_f32 v115, v228, v230
  buffer_store_dwordx4 v[112:115], v234, s[16:19], s53 offen sc0 sc1
  s_setprio 2
  s_barrier
  ds_read_b64_tr_b16 v[156:157], v2 offset:0
  ds_read_b64_tr_b16 v[158:159], v2 offset:512
  ds_read_b128 v[112:115], v1 offset:0
  ds_read_b64_tr_b16 v[160:161], v2 offset:4096
  ds_read_b64_tr_b16 v[162:163], v2 offset:4608
  ds_read_b128 v[116:119], v1 offset:128
  ds_read_b128 v[120:123], v1 offset:256
  ds_read_b128 v[124:127], v1 offset:384
  ds_read_b128 v[128:131], v1 offset:512
  ds_read_b128 v[132:135], v1 offset:640
  ds_read_b128 v[136:139], v1 offset:768
  ds_read_b128 v[140:143], v1 offset:896
  ds_read_b128 v[144:147], v1 offset:1056
  ds_read_b64_tr_b16 v[164:165], v2 offset:8192
  ds_read_b64_tr_b16 v[166:167], v2 offset:8704
  ds_read_b64_tr_b16 v[168:169], v7 offset:0
  ds_read_b64_tr_b16 v[170:171], v7 offset:512
  ds_read_b128 v[148:151], v1 offset:1184
  ds_read_b128 v[152:155], v1 offset:1312
  s_mov_b32 s56, 0
  s_waitcnt lgkmcnt(0)
  s_branch L_cloop
.p2align 6
L_cloop:
  s_waitcnt lgkmcnt(8)
  v_mfma_f32_16x16x32_bf16 v[16:19], v[156:159], v[112:115], v[16:19]
  ds_read_b64_tr_b16 v[216:217], v2 offset:12288
  v_mfma_f32_16x16x32_bf16 v[16:19], v[160:163], v[116:119], v[16:19]
  ds_read_b64_tr_b16 v[218:219], v2 offset:12800
  v_mfma_f32_16x16x32_bf16 v[20:23], v[156:159], v[116:119], v[20:23]
  ds_read_b128 v[172:175], v1 offset:64
  v_mfma_f32_16x16x32_bf16 v[20:23], v[160:163], v[120:123], v[20:23]
  ds_read_b64_tr_b16 v[220:221], v2 offset:16384
  v_mfma_f32_16x16x32_bf16 v[24:27], v[156:159], v[120:123], v[24:27]
  ds_read_b64_tr_b16 v[222:223], v2 offset:16896
  v_mfma_f32_16x16x32_bf16 v[24:27], v[160:163], v[124:127], v[24:27]
  ds_read_b128 v[176:179], v1 offset:192
  v_mfma_f32_16x16x32_bf16 v[28:31], v[156:159], v[124:127], v[28:31]
  ds_read_b128 v[180:183], v1 offset:320
  v_mfma_f32_16x16x32_bf16 v[28:31], v[160:163], v[128:131], v[28:31]
  ds_read_b128 v[184:187], v1 offset:448
  s_waitcnt lgkmcnt(12)
  v_mfma_f32_16x16x32_bf16 v[32:35], v[156:159], v[128:131], v[32:35]
  ds_read_b128 v[188:191], v1 offset:576
  v_mfma_f32_16x16x32_bf16 v[32:35], v[160:163], v[132:135], v[32:35]
  ds_read_b128 v[192:195], v1 offset:704
  v_mfma_f32_16x16x32_bf16 v[36:39], v[156:159], v[132:135], v[36:39]
  ds_read_b128 v[196:199], v1 offset:832
  v_mfma_f32_16x16x32_bf16 v[36:39], v[160:163], v[136:139], v[36:39]
  ds_read_b128 v[200:203], v1 offset:960
  v_mfma_f32_16x16x32_bf16 v[40:43], v[156:159], v[136:139], v[40:43]
  ds_read_b128 v[204:207], v1 offset:1120
  v_mfma_f32_16x16x32_bf16 v[40:43], v[160:163], v[140:143], v[40:43]
  ds_read_b64_tr_b16 v[224:225], v2 offset:20480
  v_mfma_f32_16x16x32_bf16 v[44:47], v[156:159], v[140:143], v[44:47]
  ds_read_b64_tr_b16 v[226:227], v2 offset:20992
  v_mfma_f32_16x16x32_bf16 v[44:47], v[160:163], v[144:147], v[44:47]
  ds_read_b64_tr_b16 v[228:229], v7 offset:4096
  v_mfma_f32_16x16x32_bf16 v[16:19], v[164:167], v[120:123], v[16:19]
  ds_read_b64_tr_b16 v[230:231], v7 offset:4608
  v_mfma_f32_16x16x32_bf16 v[16:19], v[168:171], v[124:127], v[16:19]
  v_mov_b32_dpp v148, v116 row_shl:1 row_mask:0xf bank_mask:0xf bound_ctrl:0
  v_mfma_f32_16x16x32_bf16 v[20:23], v[164:167], v[124:127], v[20:23]
  v_mov_b32_dpp v149, v117 row_shl:1 row_mask:0xf bank_mask:0xf bound_ctrl:0
  v_mfma_f32_16x16x32_bf16 v[20:23], v[168:171], v[128:131], v[20:23]
  v_mov_b32_dpp v150, v118 row_shl:1 row_mask:0xf bank_mask:0xf bound_ctrl:0
  v_mfma_f32_16x16x32_bf16 v[24:27], v[164:167], v[128:131], v[24:27]
  v_mov_b32_dpp v151, v119 row_shl:1 row_mask:0xf bank_mask:0xf bound_ctrl:0
  v_mfma_f32_16x16x32_bf16 v[24:27], v[168:171], v[132:135], v[24:27]
  v_mov_b32_dpp v152, v120 row_shl:1 row_mask:0xf bank_mask:0xf bound_ctrl:0
  v_mfma_f32_16x16x32_bf16 v[28:31], v[164:167], v[132:135], v[28:31]
  v_mov_b32_dpp v153, v121 row_shl:1 row_mask:0xf bank_mask:0xf bound_ctrl:0
  v_mfma_f32_16x16x32_bf16 v[28:31], v[168:171], v[136:139], v[28:31]
  v_mov_b32_dpp v154, v122 row_shl:1 row_mask:0xf bank_mask:0xf bound_ctrl:0
  v_mfma_f32_16x16x32_bf16 v[32:35], v[164:167], v[136:139], v[32:35]
  v_mov_b32_dpp v155, v123 row_shl:1 row_mask:0xf bank_mask:0xf bound_ctrl:0
  v_mfma_f32_16x16x32_bf16 v[32:35], v[168:171], v[140:143], v[32:35]
  s_waitcnt lgkmcnt(10)
  v_mov_b32_dpp v208, v176 row_shl:1 row_mask:0xf bank_mask:0xf bound_ctrl:0
  v_mfma_f32_16x16x32_bf16 v[36:39], v[164:167], v[140:143], v[36:39]
  v_mov_b32_dpp v209, v177 row_shl:1 row_mask:0xf bank_mask:0xf bound_ctrl:0
  v_mfma_f32_16x16x32_bf16 v[36:39], v[168:171], v[144:147], v[36:39]
  v_mov_b32_dpp v210, v178 row_shl:1 row_mask:0xf bank_mask:0xf bound_ctrl:0
  v_mfma_f32_16x16x32_bf16 v[40:43], v[164:167], v[144:147], v[40:43]
  v_mov_b32_dpp v211, v179 row_shl:1 row_mask:0xf bank_mask:0xf bound_ctrl:0
  v_mfma_f32_16x16x32_bf16 v[40:43], v[168:171], v[148:151], v[40:43]
  v_mov_b32_dpp v212, v180 row_shl:1 row_mask:0xf bank_mask:0xf bound_ctrl:0
  v_mfma_f32_16x16x32_bf16 v[44:47], v[164:167], v[148:151], v[44:47]
  v_mov_b32_dpp v213, v181 row_shl:1 row_mask:0xf bank_mask:0xf bound_ctrl:0
  v_mfma_f32_16x16x32_bf16 v[44:47], v[168:171], v[152:155], v[44:47]
  v_mov_b32_dpp v214, v182 row_shl:1 row_mask:0xf bank_mask:0xf bound_ctrl:0
  v_mov_b32_dpp v215, v183 row_shl:1 row_mask:0xf bank_mask:0xf bound_ctrl:0
  s_waitcnt lgkmcnt(11)
  v_mfma_f32_16x16x32_bf16 v[16:19], v[216:219], v[172:175], v[16:19]
  v_mfma_f32_16x16x32_bf16 v[16:19], v[220:223], v[176:179], v[16:19]
  s_waitcnt vmcnt(0) lgkmcnt(0)
  s_barrier
  v_mfma_f32_16x16x32_bf16 v[20:23], v[216:219], v[176:179], v[20:23]
  v_mfma_f32_16x16x32_bf16 v[20:23], v[220:223], v[180:183], v[20:23]
  v_mfma_f32_16x16x32_bf16 v[24:27], v[216:219], v[180:183], v[24:27]
  v_mfma_f32_16x16x32_bf16 v[24:27], v[220:223], v[184:187], v[24:27]
  v_mfma_f32_16x16x32_bf16 v[28:31], v[216:219], v[184:187], v[28:31]
  v_mfma_f32_16x16x32_bf16 v[28:31], v[220:223], v[188:191], v[28:31]
  v_mfma_f32_16x16x32_bf16 v[32:35], v[216:219], v[188:191], v[32:35]
  v_mfma_f32_16x16x32_bf16 v[32:35], v[220:223], v[192:195], v[32:35]
  v_mfma_f32_16x16x32_bf16 v[36:39], v[216:219], v[192:195], v[36:39]
  v_mfma_f32_16x16x32_bf16 v[36:39], v[220:223], v[196:199], v[36:39]
  v_mfma_f32_16x16x32_bf16 v[40:43], v[216:219], v[196:199], v[40:43]
  v_mfma_f32_16x16x32_bf16 v[40:43], v[220:223], v[200:203], v[40:43]
  ds_read_b64_tr_b16 v[156:157], v4 offset:0
  v_mfma_f32_16x16x32_bf16 v[44:47], v[216:219], v[200:203], v[44:47]
  ds_read_b64_tr_b16 v[158:159], v4 offset:512
  v_mfma_f32_16x16x32_bf16 v[44:47], v[220:223], v[204:207], v[44:47]
  ds_read_b128 v[112:115], v3 offset:0
  v_mfma_f32_16x16x32_bf16 v[16:19], v[224:227], v[180:183], v[16:19]
  ds_read_b64_tr_b16 v[160:161], v4 offset:4096
  v_mfma_f32_16x16x32_bf16 v[16:19], v[228:231], v[184:187], v[16:19]
  ds_read_b64_tr_b16 v[162:163], v4 offset:4608
  v_mfma_f32_16x16x32_bf16 v[20:23], v[224:227], v[184:187], v[20:23]
  ds_read_b128 v[116:119], v3 offset:128
  v_mfma_f32_16x16x32_bf16 v[20:23], v[228:231], v[188:191], v[20:23]
  ds_read_b64_tr_b16 v[164:165], v4 offset:8192
  v_mfma_f32_16x16x32_bf16 v[24:27], v[224:227], v[188:191], v[24:27]
  ds_read_b64_tr_b16 v[166:167], v4 offset:8704
  v_mfma_f32_16x16x32_bf16 v[24:27], v[228:231], v[192:195], v[24:27]
  ds_read_b128 v[120:123], v3 offset:256
  v_mfma_f32_16x16x32_bf16 v[28:31], v[224:227], v[192:195], v[28:31]
  ds_read_b128 v[124:127], v3 offset:384
  v_mfma_f32_16x16x32_bf16 v[28:31], v[228:231], v[196:199], v[28:31]
  ds_read_b128 v[128:131], v3 offset:512
  v_mfma_f32_16x16x32_bf16 v[32:35], v[224:227], v[196:199], v[32:35]
  ds_read_b128 v[132:135], v3 offset:640
  v_mfma_f32_16x16x32_bf16 v[32:35], v[228:231], v[200:203], v[32:35]
  ds_read_b128 v[136:139], v3 offset:768
  v_mfma_f32_16x16x32_bf16 v[36:39], v[224:227], v[200:203], v[36:39]
  ds_read_b128 v[140:143], v3 offset:896
  v_mfma_f32_16x16x32_bf16 v[36:39], v[228:231], v[204:207], v[36:39]
  ds_read_b128 v[144:147], v3 offset:1056
  v_mfma_f32_16x16x32_bf16 v[40:43], v[224:227], v[204:207], v[40:43]
  ds_read_b128 v[148:151], v3 offset:1184
  v_sub_u32 v7, v8, v7
  v_mfma_f32_16x16x32_bf16 v[40:43], v[228:231], v[208:211], v[40:43]
  ds_read_b64_tr_b16 v[168:169], v4 offset:24576
  v_mfma_f32_16x16x32_bf16 v[44:47], v[224:227], v[208:211], v[44:47]
  ds_read_b64_tr_b16 v[170:171], v4 offset:25088
  v_mfma_f32_16x16x32_bf16 v[44:47], v[228:231], v[212:215], v[44:47]
  ds_read_b128 v[152:155], v3 offset:1312
  s_bitcmp1_b32 s56, 0
  s_waitcnt lgkmcnt(9)
  v_mfma_f32_16x16x32_bf16 v[48:51], v[156:159], v[112:115], v[48:51]
  ds_read_b64_tr_b16 v[216:217], v4 offset:12288
  v_mfma_f32_16x16x32_bf16 v[48:51], v[160:163], v[116:119], v[48:51]
  ds_read_b64_tr_b16 v[218:219], v4 offset:12800
  v_mfma_f32_16x16x32_bf16 v[48:51], v[164:167], v[120:123], v[48:51]
  ds_read_b128 v[172:175], v3 offset:64
  v_mfma_f32_16x16x32_bf16 v[52:55], v[164:167], v[124:127], v[52:55]
  ds_read_b64_tr_b16 v[220:221], v4 offset:16384
  v_mfma_f32_16x16x32_bf16 v[52:55], v[160:163], v[120:123], v[52:55]
  ds_read_b64_tr_b16 v[222:223], v4 offset:16896
  v_mfma_f32_16x16x32_bf16 v[52:55], v[156:159], v[116:119], v[52:55]
  ds_read_b128 v[176:179], v3 offset:192
  v_mfma_f32_16x16x32_bf16 v[56:59], v[156:159], v[120:123], v[56:59]
  ds_read_b64_tr_b16 v[224:225], v4 offset:20480
  v_mfma_f32_16x16x32_bf16 v[56:59], v[160:163], v[124:127], v[56:59]
  ds_read_b64_tr_b16 v[226:227], v4 offset:20992
  s_waitcnt lgkmcnt(13)
  v_mfma_f32_16x16x32_bf16 v[56:59], v[164:167], v[128:131], v[56:59]
  ds_read_b128 v[180:183], v3 offset:320
  v_mfma_f32_16x16x32_bf16 v[60:63], v[164:167], v[132:135], v[60:63]
  ds_read_b128 v[184:187], v3 offset:448
  v_mfma_f32_16x16x32_bf16 v[60:63], v[160:163], v[128:131], v[60:63]
  ds_read_b128 v[188:191], v3 offset:576
  v_mfma_f32_16x16x32_bf16 v[60:63], v[156:159], v[124:127], v[60:63]
  ds_read_b128 v[192:195], v3 offset:704
  v_mfma_f32_16x16x32_bf16 v[64:67], v[156:159], v[128:131], v[64:67]
  ds_read_b128 v[196:199], v3 offset:832
  v_mfma_f32_16x16x32_bf16 v[64:67], v[160:163], v[132:135], v[64:67]
  ds_read_b128 v[200:203], v3 offset:960
  v_mfma_f32_16x16x32_bf16 v[64:67], v[164:167], v[136:139], v[64:67]
  ds_read_b128 v[204:207], v3 offset:1120
  v_mfma_f32_16x16x32_bf16 v[68:71], v[164:167], v[140:143], v[68:71]
  ds_read_b128 v[208:211], v3 offset:1248
  v_mfma_f32_16x16x32_bf16 v[68:71], v[160:163], v[136:139], v[68:71]
  ds_read_b64_tr_b16 v[228:229], v4 offset:28672
  v_mfma_f32_16x16x32_bf16 v[68:71], v[156:159], v[132:135], v[68:71]
  ds_read_b64_tr_b16 v[230:231], v4 offset:29184
  v_mfma_f32_16x16x32_bf16 v[72:75], v[156:159], v[136:139], v[72:75]
  v_mfma_f32_16x16x32_bf16 v[72:75], v[160:163], v[140:143], v[72:75]
  ds_read_b128 v[212:215], v3 offset:1376
  v_mfma_f32_16x16x32_bf16 v[72:75], v[164:167], v[144:147], v[72:75]
  v_mfma_f32_16x16x32_bf16 v[76:79], v[164:167], v[148:151], v[76:79]
  v_mfma_f32_16x16x32_bf16 v[76:79], v[160:163], v[144:147], v[76:79]
  v_mfma_f32_16x16x32_bf16 v[76:79], v[156:159], v[140:143], v[76:79]
  s_cbranch_scc1 L_skipa
  v_mfma_f32_16x16x32_bf16 v[48:51], v[168:171], v[124:127], v[48:51]
  v_mfma_f32_16x16x32_bf16 v[52:55], v[168:171], v[128:131], v[52:55]
  v_mfma_f32_16x16x32_bf16 v[56:59], v[168:171], v[132:135], v[56:59]
  v_mfma_f32_16x16x32_bf16 v[60:63], v[168:171], v[136:139], v[60:63]
  v_mfma_f32_16x16x32_bf16 v[64:67], v[168:171], v[140:143], v[64:67]
  v_mfma_f32_16x16x32_bf16 v[68:71], v[168:171], v[144:147], v[68:71]
  v_mfma_f32_16x16x32_bf16 v[72:75], v[168:171], v[148:151], v[72:75]
  v_mfma_f32_16x16x32_bf16 v[76:79], v[168:171], v[152:155], v[76:79]
L_skipa:
  s_waitcnt lgkmcnt(13)
  v_mfma_f32_16x16x32_bf16 v[48:51], v[216:219], v[172:175], v[48:51]
  v_mfma_f32_16x16x32_bf16 v[48:51], v[220:223], v[176:179], v[48:51]
  s_waitcnt lgkmcnt(0)
  s_barrier
  ds_read_b64_tr_b16 v[156:157], v6 offset:0
  v_mfma_f32_16x16x32_bf16 v[48:51], v[224:227], v[180:183], v[48:51]
  ds_read_b64_tr_b16 v[158:159], v6 offset:512
  v_mfma_f32_16x16x32_bf16 v[52:55], v[224:227], v[184:187], v[52:55]
  ds_read_b128 v[112:115], v5 offset:0
  v_mfma_f32_16x16x32_bf16 v[52:55], v[220:223], v[180:183], v[52:55]
  ds_read_b64_tr_b16 v[160:161], v6 offset:4096
  v_mfma_f32_16x16x32_bf16 v[52:55], v[216:219], v[176:179], v[52:55]
  ds_read_b64_tr_b16 v[162:163], v6 offset:4608
  v_mfma_f32_16x16x32_bf16 v[56:59], v[216:219], v[180:183], v[56:59]
  ds_read_b128 v[116:119], v5 offset:128
  v_mfma_f32_16x16x32_bf16 v[56:59], v[220:223], v[184:187], v[56:59]
  ds_read_b128 v[120:123], v5 offset:256
  v_mfma_f32_16x16x32_bf16 v[56:59], v[224:227], v[188:191], v[56:59]
  ds_read_b128 v[124:127], v5 offset:384
  v_mfma_f32_16x16x32_bf16 v[60:63], v[224:227], v[192:195], v[60:63]
  ds_read_b128 v[128:131], v5 offset:512
  v_mfma_f32_16x16x32_bf16 v[60:63], v[220:223], v[188:191], v[60:63]
  ds_read_b128 v[132:135], v5 offset:640
  v_mfma_f32_16x16x32_bf16 v[60:63], v[216:219], v[184:187], v[60:63]
  ds_read_b128 v[136:139], v5 offset:768
  v_mfma_f32_16x16x32_bf16 v[64:67], v[216:219], v[188:191], v[64:67]
  ds_read_b128 v[140:143], v5 offset:896
  v_mfma_f32_16x16x32_bf16 v[64:67], v[220:223], v[192:195], v[64:67]
  ds_read_b128 v[144:147], v5 offset:1056
  v_mfma_f32_16x16x32_bf16 v[64:67], v[224:227], v[196:199], v[64:67]
  ds_read_b64_tr_b16 v[164:165], v6 offset:8192
  v_mfma_f32_16x16x32_bf16 v[68:71], v[224:227], v[200:203], v[68:71]
  ds_read_b64_tr_b16 v[166:167], v6 offset:8704
  v_mfma_f32_16x16x32_bf16 v[68:71], v[220:223], v[196:199], v[68:71]
  ds_read_b64_tr_b16 v[168:169], v6 offset:24576
  v_mfma_f32_16x16x32_bf16 v[68:71], v[216:219], v[192:195], v[68:71]
  ds_read_b64_tr_b16 v[170:171], v6 offset:25088
  v_mfma_f32_16x16x32_bf16 v[72:75], v[216:219], v[196:199], v[72:75]
  ds_read_b128 v[148:151], v5 offset:1184
  v_mfma_f32_16x16x32_bf16 v[72:75], v[220:223], v[200:203], v[72:75]
  ds_read_b128 v[152:155], v5 offset:1312
  v_mfma_f32_16x16x32_bf16 v[72:75], v[224:227], v[204:207], v[72:75]
  v_mfma_f32_16x16x32_bf16 v[76:79], v[224:227], v[208:211], v[76:79]
  v_mfma_f32_16x16x32_bf16 v[76:79], v[220:223], v[204:207], v[76:79]
  v_mfma_f32_16x16x32_bf16 v[76:79], v[216:219], v[200:203], v[76:79]
  s_cbranch_scc1 L_skipb
  v_mfma_f32_16x16x32_bf16 v[48:51], v[228:231], v[184:187], v[48:51]
  v_mfma_f32_16x16x32_bf16 v[52:55], v[228:231], v[188:191], v[52:55]
  v_mfma_f32_16x16x32_bf16 v[56:59], v[228:231], v[192:195], v[56:59]
  v_mfma_f32_16x16x32_bf16 v[60:63], v[228:231], v[196:199], v[60:63]
  v_mfma_f32_16x16x32_bf16 v[64:67], v[228:231], v[200:203], v[64:67]
  v_mfma_f32_16x16x32_bf16 v[68:71], v[228:231], v[204:207], v[68:71]
  v_mfma_f32_16x16x32_bf16 v[72:75], v[228:231], v[208:211], v[72:75]
  v_mfma_f32_16x16x32_bf16 v[76:79], v[228:231], v[212:215], v[76:79]
L_skipb:
  s_cmp_eq_u32 s56, 0
  s_cbranch_scc1 L_cfirst
L_gs:
  s_waitcnt lgkmcnt(10)
  v_mfma_f32_16x16x32_bf16 v[80:83], v[156:159], v[112:115], v[80:83]
  ds_read_b64_tr_b16 v[216:217], v6 offset:12288
  v_mfma_f32_16x16x32_bf16 v[80:83], v[160:163], v[116:119], v[80:83]
  ds_read_b64_tr_b16 v[218:219], v6 offset:12800
  v_mfma_f32_16x16x32_bf16 v[84:87], v[156:159], v[116:119], v[84:87]
  ds_read_b128 v[172:175], v5 offset:64
  v_mfma_f32_16x16x32_bf16 v[84:87], v[160:163], v[120:123], v[84:87]
  ds_read_b64_tr_b16 v[220:221], v6 offset:16384
  v_mfma_f32_16x16x32_bf16 v[88:91], v[156:159], v[120:123], v[88:91]
  ds_read_b64_tr_b16 v[222:223], v6 offset:16896
  v_mfma_f32_16x16x32_bf16 v[88:91], v[160:163], v[124:127], v[88:91]
  ds_read_b128 v[176:179], v5 offset:192
  v_mfma_f32_16x16x32_bf16 v[92:95], v[156:159], v[124:127], v[92:95]
  ds_read_b128 v[180:183], v5 offset:320
  v_mfma_f32_16x16x32_bf16 v[92:95], v[160:163], v[128:131], v[92:95]
  ds_read_b128 v[184:187], v5 offset:448
  s_waitcnt lgkmcnt(14)
  v_mfma_f32_16x16x32_bf16 v[96:99], v[156:159], v[128:131], v[96:99]
  ds_read_b128 v[188:191], v5 offset:576
  v_mfma_f32_16x16x32_bf16 v[96:99], v[160:163], v[132:135], v[96:99]
  ds_read_b128 v[192:195], v5 offset:704
  v_mfma_f32_16x16x32_bf16 v[100:103], v[156:159], v[132:135], v[100:103]
  ds_read_b128 v[196:199], v5 offset:832
  v_mfma_f32_16x16x32_bf16 v[100:103], v[160:163], v[136:139], v[100:103]
  ds_read_b128 v[200:203], v5 offset:960
  v_mfma_f32_16x16x32_bf16 v[104:107], v[156:159], v[136:139], v[104:107]
  ds_read_b64_tr_b16 v[224:225], v6 offset:20480
  v_mfma_f32_16x16x32_bf16 v[104:107], v[160:163], v[140:143], v[104:107]
  ds_read_b64_tr_b16 v[226:227], v6 offset:20992
  v_mfma_f32_16x16x32_bf16 v[108:111], v[156:159], v[140:143], v[108:111]
  ds_read_b64_tr_b16 v[228:229], v6 offset:28672
  v_mfma_f32_16x16x32_bf16 v[108:111], v[160:163], v[144:147], v[108:111]
  ds_read_b64_tr_b16 v[230:231], v6 offset:29184
  v_mfma_f32_16x16x32_bf16 v[80:83], v[164:167], v[120:123], v[80:83]
  s_waitcnt lgkmcnt(9)
  v_mov_b32_dpp v204, v172 row_shl:1 row_mask:0xf bank_mask:0xf bound_ctrl:0
  v_mfma_f32_16x16x32_bf16 v[80:83], v[168:171], v[124:127], v[80:83]
  v_mov_b32_dpp v205, v173 row_shl:1 row_mask:0xf bank_mask:0xf bound_ctrl:0
  v_mfma_f32_16x16x32_bf16 v[84:87], v[164:167], v[124:127], v[84:87]
  v_mov_b32_dpp v206, v174 row_shl:1 row_mask:0xf bank_mask:0xf bound_ctrl:0
  v_mfma_f32_16x16x32_bf16 v[84:87], v[168:171], v[128:131], v[84:87]
  v_mov_b32_dpp v207, v175 row_shl:1 row_mask:0xf bank_mask:0xf bound_ctrl:0
  v_mfma_f32_16x16x32_bf16 v[88:91], v[164:167], v[128:131], v[88:91]
  v_mov_b32_dpp v208, v176 row_shl:1 row_mask:0xf bank_mask:0xf bound_ctrl:0
  v_mfma_f32_16x16x32_bf16 v[88:91], v[168:171], v[132:135], v[88:91]
  v_mov_b32_dpp v209, v177 row_shl:1 row_mask:0xf bank_mask:0xf bound_ctrl:0
  v_mfma_f32_16x16x32_bf16 v[92:95], v[164:167], v[132:135], v[92:95]
  v_mov_b32_dpp v210, v178 row_shl:1 row_mask:0xf bank_mask:0xf bound_ctrl:0
  v_mfma_f32_16x16x32_bf16 v[92:95], v[168:171], v[136:139], v[92:95]
  v_mov_b32_dpp v211, v179 row_shl:1 row_mask:0xf bank_mask:0xf bound_ctrl:0
  v_mfma_f32_16x16x32_bf16 v[96:99], v[164:167], v[136:139], v[96:99]
  v_mov_b32_dpp v212, v180 row_shl:1 row_mask:0xf bank_mask:0xf bound_ctrl:0
  v_mfma_f32_16x16x32_bf16 v[96:99], v[168:171], v[140:143], v[96:99]
  v_mov_b32_dpp v213, v181 row_shl:1 row_mask:0xf bank_mask:0xf bound_ctrl:0
  v_mfma_f32_16x16x32_bf16 v[100:103], v[164:167], v[140:143], v[100:103]
  v_mov_b32_dpp v214, v182 row_shl:1 row_mask:0xf bank_mask:0xf bound_ctrl:0
  v_mfma_f32_16x16x32_bf16 v[100:103], v[168:171], v[144:147], v[100:103]
  v_mov_b32_dpp v215, v183 row_shl:1 row_mask:0xf bank_mask:0xf bound_ctrl:0
  v_mfma_f32_16x16x32_bf16 v[104:107], v[164:167], v[144:147], v[104:107]
  v_mfma_f32_16x16x32_bf16 v[104:107], v[168:171], v[148:151], v[104:107]
  v_mfma_f32_16x16x32_bf16 v[108:111], v[164:167], v[148:151], v[108:111]
  v_mfma_f32_16x16x32_bf16 v[108:111], v[168:171], v[152:155], v[108:111]
  s_add_u32 s56, s56, 1
  s_cmp_lt_u32 s56, 8
  s_waitcnt lgkmcnt(10)
  v_mfma_f32_16x16x32_bf16 v[80:83], v[216:219], v[172:175], v[80:83]
  v_mfma_f32_16x16x32_bf16 v[80:83], v[220:223], v[176:179], v[80:83]
  s_waitcnt lgkmcnt(0)
  s_barrier
  v_mfma_f32_16x16x32_bf16 v[84:87], v[216:219], v[176:179], v[84:87]
  v_mfma_f32_16x16x32_bf16 v[84:87], v[220:223], v[180:183], v[84:87]
  v_mfma_f32_16x16x32_bf16 v[88:91], v[216:219], v[180:183], v[88:91]
  v_mfma_f32_16x16x32_bf16 v[88:91], v[220:223], v[184:187], v[88:91]
  v_mfma_f32_16x16x32_bf16 v[92:95], v[216:219], v[184:187], v[92:95]
  v_mfma_f32_16x16x32_bf16 v[92:95], v[220:223], v[188:191], v[92:95]
  v_mfma_f32_16x16x32_bf16 v[96:99], v[216:219], v[188:191], v[96:99]
  v_mfma_f32_16x16x32_bf16 v[96:99], v[220:223], v[192:195], v[96:99]
  v_mfma_f32_16x16x32_bf16 v[100:103], v[216:219], v[192:195], v[100:103]
  v_mfma_f32_16x16x32_bf16 v[100:103], v[220:223], v[196:199], v[100:103]
  v_mfma_f32_16x16x32_bf16 v[104:107], v[216:219], v[196:199], v[104:107]
  v_mfma_f32_16x16x32_bf16 v[104:107], v[220:223], v[200:203], v[104:107]
  v_mfma_f32_16x16x32_bf16 v[108:111], v[216:219], v[200:203], v[108:111]
  v_mfma_f32_16x16x32_bf16 v[108:111], v[220:223], v[204:207], v[108:111]
  ds_read_b64_tr_b16 v[156:157], v2 offset:0
  v_mfma_f32_16x16x32_bf16 v[80:83], v[224:227], v[180:183], v[80:83]
  ds_read_b64_tr_b16 v[158:159], v2 offset:512
  v_mfma_f32_16x16x32_bf16 v[80:83], v[228:231], v[184:187], v[80:83]
  ds_read_b128 v[112:115], v1 offset:0
  v_mfma_f32_16x16x32_bf16 v[84:87], v[224:227], v[184:187], v[84:87]
  ds_read_b64_tr_b16 v[160:161], v2 offset:4096
  v_mfma_f32_16x16x32_bf16 v[84:87], v[228:231], v[188:191], v[84:87]
  ds_read_b64_tr_b16 v[162:163], v2 offset:4608
  v_mfma_f32_16x16x32_bf16 v[88:91], v[224:227], v[188:191], v[88:91]
  ds_read_b128 v[116:119], v1 offset:128
  v_mfma_f32_16x16x32_bf16 v[88:91], v[228:231], v[192:195], v[88:91]
  ds_read_b128 v[120:123], v1 offset:256
  v_mfma_f32_16x16x32_bf16 v[92:95], v[224:227], v[192:195], v[92:95]
  ds_read_b128 v[124:127], v1 offset:384
  v_mfma_f32_16x16x32_bf16 v[92:95], v[228:231], v[196:199], v[92:95]
  ds_read_b128 v[128:131], v1 offset:512
  v_mfma_f32_16x16x32_bf16 v[96:99], v[224:227], v[196:199], v[96:99]
  ds_read_b128 v[132:135], v1 offset:640
  v_mfma_f32_16x16x32_bf16 v[96:99], v[228:231], v[200:203], v[96:99]
  ds_read_b128 v[136:139], v1 offset:768
  v_mfma_f32_16x16x32_bf16 v[100:103], v[224:227], v[200:203], v[100:103]
  ds_read_b128 v[140:143], v1 offset:896
  v_mfma_f32_16x16x32_bf16 v[100:103], v[228:231], v[204:207], v[100:103]
  ds_read_b128 v[144:147], v1 offset:1056
  v_mfma_f32_16x16x32_bf16 v[104:107], v[224:227], v[204:207], v[104:107]
  ds_read_b64_tr_b16 v[164:165], v2 offset:8192
  v_mfma_f32_16x16x32_bf16 v[104:107], v[228:231], v[208:211], v[104:107]
  ds_read_b64_tr_b16 v[166:167], v2 offset:8704
  v_mfma_f32_16x16x32_bf16 v[108:111], v[224:227], v[208:211], v[108:111]
  ds_read_b64_tr_b16 v[168:169], v7 offset:0
  v_mfma_f32_16x16x32_bf16 v[108:111], v[228:231], v[212:215], v[108:111]
  ds_read_b64_tr_b16 v[170:171], v7 offset:512
  s_cbranch_scc1 L_cloop
  s_branch L_cdone
L_cfirst:
  v_add_u32 v1, 99584, v1
  v_subrev_u32 v3, 49792, v3
  v_subrev_u32 v5, 49792, v5
  v_add_u32 v2, 99584, v2
  v_subrev_u32 v4, 49792, v4
  v_subrev_u32 v6, 49792, v6
  v_add_u32 v7, 24576, v2
  s_mov_b32 s56, 1
  s_waitcnt lgkmcnt(0)
  s_branch L_cloop
.p2align 6
L_lloop:
  s_cmp_eq_u32 s60, 3
  s_cbranch_scc1 L_last
  s_setprio 3
  ds_write_b128 v4, v[80:83] offset:49792
  ds_write_b128 v4, v[84:87] offset:50848
  s_setprio 0
  s_add_u32 m0, s73, 66816
  s_add_u32 s55, s53, 524288
  buffer_load_dwordx4 v3, s[16:19], s55 offen sc1 lds
  s_add_u32 m0, s73, 70912
  s_add_u32 s55, s53, 655360
  buffer_load_dwordx4 v3, s[16:19], s55 offen sc1 lds
  s_add_u32 m0, s73, 75008
  s_add_u32 s55, s53, 786432
  buffer_load_dwordx4 v3, s[16:19], s55 offen sc1 lds
  s_add_u32 m0, s73, 91392
  s_add_u32 s55, s53, 917504
  buffer_load_dwordx4 v3, s[16:19], s55 offen sc1 lds
  s_add_u32 m0, s73, 79104
  s_add_u32 s55, s53, 540672
  buffer_load_dwordx4 v3, s[16:19], s55 offen sc1 lds
  s_add_u32 m0, s73, 83200
  s_add_u32 s55, s53, 671744
  buffer_load_dwordx4 v3, s[16:19], s55 offen sc1 lds
  s_add_u32 m0, s73, 87296
  s_add_u32 s55, s53, 802816
  buffer_load_dwordx4 v3, s[16:19], s55 offen sc1 lds
  s_add_u32 m0, s73, 95488
  s_add_u32 s55, s53, 933888
  buffer_load_dwordx4 v3, s[16:19], s55 offen sc1 lds
  s_add_u32 m0, s73, 149376
  s_add_u32 s55, s50, 1572864
  buffer_load_dwordx4 v3, s[8:11], s55 offen lds
  s_add_u32 m0, s73, 153472
  s_add_u32 s55, s50, 1589248
  buffer_load_dwordx4 v3, s[8:11], s55 offen lds
  ds_read_b128 v[16:19], v6 offset:0
  ds_read_b128 v[20:23], v6 offset:1056
  ds_read_b128 v[24:27], v6 offset:2112
  ds_read_b128 v[28:31], v6 offset:3168
  s_cmp_lt_u32 s60, 3
  s_cselect_b32 s56, s61, 1073741824
  s_lshl_b32 s55, s60, 7
  s_add_u32 s55, s55, s56
  s_add_u32 s55, s55, 640
  s_mov_b64 exec, 0xffff
  buffer_load_dword v66, v15, s[4:7], s55 offen
  s_mov_b64 exec, -1
  s_waitcnt vmcnt(11)
L_join:
  ds_read_b128 v[32:35], v4 offset:0
  ds_read_b128 v[36:39], v4 offset:1056
  ds_read_b128 v[40:43], v4 offset:2112
  ds_read_b128 v[44:47], v4 offset:3168
  s_mov_b32 s53, s52
  s_add_u32 s60, s60, 1
  s_mov_b32 s52, s50
  s_add_u32 s50, s50, 32768
  s_cmp_eq_u32 s60, 3
  s_cselect_b32 s50, 1073741824, s50
  s_add_u32 s51, s51, 128
  s_waitcnt lgkmcnt(0)
  s_barrier
  s_setprio 3
  ds_write_b128 v4, v[88:91] offset:51904
  ds_write_b128 v4, v[92:95] offset:52960
  s_setprio 0
  s_cmp_lg_u32 s46, 0
  s_cbranch_scc1 L_nt3
  s_mov_b32 m0, 116480
  s_add_u32 s55, s51, 262144
  s_mov_b64 exec, 0xff
  buffer_load_dwordx4 v1, s[4:7], s55 offen lds
  s_mov_b64 exec, -1
  L_nt3:
  s_add_u32 m0, s74, 99584
  s_add_u32 s55, s51, 0
  buffer_load_dwordx4 v1, s[4:7], s55 offen lds
  v_lshlrev_b32 v48, 16, v32
  v_lshlrev_b32 v49, 16, v16
  v_and_b32 v50, s57, v32
  v_and_b32 v51, s57, v16
  v_lshlrev_b32 v52, 16, v33
  s_add_u32 m0, s74, 100640
  s_add_u32 s55, s51, 16384
  buffer_load_dwordx4 v1, s[4:7], s55 offen lds
  v_lshlrev_b32 v53, 16, v17
  v_and_b32 v54, s57, v33
  v_and_b32 v55, s57, v17
  v_sub_f32 v48, v48, v49
  v_sub_f32 v50, v50, v51
  v_sub_f32 v52, v52, v53
  s_add_u32 m0, s74, 101696
  s_add_u32 s55, s51, 32768
  buffer_load_dwordx4 v1, s[4:7], s55 offen lds
  v_sub_f32 v54, v54, v55
  v_cvt_pk_bf16_f32 v80, v48, v50
  v_cvt_pk_bf16_f32 v81, v52, v54
  v_lshlrev_b32 v48, 16, v34
  v_lshlrev_b32 v49, 16, v18
  s_add_u32 m0, s74, 102752
  s_add_u32 s55, s51, 49152
  buffer_load_dwordx4 v1, s[4:7], s55 offen lds
  v_and_b32 v50, s57, v34
  v_and_b32 v51, s57, v18
  v_lshlrev_b32 v52, 16, v35
  v_lshlrev_b32 v53, 16, v19
  v_and_b32 v54, s57, v35
  v_and_b32 v55, s57, v19
  s_add_u32 m0, s73, 116608
  s_add_u32 s55, s52, 0
  buffer_load_dwordx4 v3, s[8:11], s55 offen lds
  v_sub_f32 v48, v48, v49
  v_sub_f32 v50, v50, v51
  v_sub_f32 v52, v52, v53
  v_sub_f32 v54, v54, v55
  v_cvt_pk_bf16_f32 v82, v48, v50
  v_cvt_pk_bf16_f32 v83, v52, v54
  s_add_u32 m0, s73, 120704
  s_add_u32 s55, s52, 524288
  buffer_load_dwordx4 v3, s[8:11], s55 offen lds
  v_lshlrev_b32 v48, 16, v36
  v_lshlrev_b32 v49, 16, v20
  v_and_b32 v50, s57, v36
  v_and_b32 v51, s57, v20
  v_lshlrev_b32 v52, 16, v37
  s_add_u32 m0, s73, 124800
  s_add_u32 s55, s52, 1048576
  buffer_load_dwordx4 v3, s[8:11], s55 offen lds
  v_lshlrev_b32 v53, 16, v21
  v_and_b32 v54, s57, v37
  v_and_b32 v55, s57, v21
  v_sub_f32 v48, v48, v49
  v_sub_f32 v50, v50, v51
  v_sub_f32 v52, v52, v53
  s_add_u32 m0, s73, 128896
  s_add_u32 s55, s52, 16384
  buffer_load_dwordx4 v3, s[8:11], s55 offen lds
  v_sub_f32 v54, v54, v55
  v_cvt_pk_bf16_f32 v84, v48, v50
  v_cvt_pk_bf16_f32 v85, v52, v54
  v_lshlrev_b32 v48, 16, v38
  v_lshlrev_b32 v49, 16, v22
  s_add_u32 m0, s73, 132992
  s_add_u32 s55, s52, 540672
  buffer_load_dwordx4 v3, s[8:11], s55 offen lds
  v_and_b32 v50, s57, v38
  v_and_b32 v51, s57, v22
  v_lshlrev_b32 v52, 16, v39
  v_lshlrev_b32 v53, 16, v23
  v_and_b32 v54, s57, v39
  v_and_b32 v55, s57, v23
  s_add_u32 m0, s73, 137088
  s_add_u32 s55, s52, 1064960
  buffer_load_dwordx4 v3, s[8:11], s55 offen lds
  v_sub_f32 v48, v48, v49
  v_sub_f32 v50, v50, v51
  v_sub_f32 v52, v52, v53
  v_sub_f32 v54, v54, v55
  v_cvt_pk_bf16_f32 v86, v48, v50
  v_cvt_pk_bf16_f32 v87, v52, v54
  s_waitcnt vmcnt(13) lgkmcnt(0)
  s_barrier
  s_cmp_lg_u32 s60, 1
  s_cbranch_scc1 L_nf2
  buffer_load_dwordx2 v[56:57], v8, s[16:19], s67 offen sc0 sc1
L_nf2:
  s_add_u32 m0, s74, 0
  s_add_u32 s55, s51, 1024
  buffer_load_dwordx4 v1, s[4:7], s55 offen lds
  v_lshlrev_b32 v48, 16, v40
  v_lshlrev_b32 v49, 16, v24
  v_and_b32 v50, s57, v40
  v_and_b32 v51, s57, v24
  v_lshlrev_b32 v52, 16, v41
  s_add_u32 m0, s74, 1056
  s_add_u32 s55, s51, 17408
  buffer_load_dwordx4 v1, s[4:7], s55 offen lds
  v_lshlrev_b32 v53, 16, v25
  v_and_b32 v54, s57, v41
  v_and_b32 v55, s57, v25
  v_sub_f32 v48, v48, v49
  v_sub_f32 v50, v50, v51
  v_sub_f32 v52, v52, v53
  s_add_u32 m0, s74, 2112
  s_add_u32 s55, s51, 33792
  buffer_load_dwordx4 v1, s[4:7], s55 offen lds
  v_sub_f32 v54, v54, v55
  v_cvt_pk_bf16_f32 v88, v48, v50
  v_cvt_pk_bf16_f32 v89, v52, v54
  v_lshlrev_b32 v48, 16, v42
  v_lshlrev_b32 v49, 16, v26
  s_add_u32 m0, s74, 3168
  s_add_u32 s55, s51, 50176
  buffer_load_dwordx4 v1, s[4:7], s55 offen lds
  v_and_b32 v50, s57, v42
  v_and_b32 v51, s57, v26
  v_lshlrev_b32 v52, 16, v43
  v_lshlrev_b32 v53, 16, v27
  v_and_b32 v54, s57, v43
  v_and_b32 v55, s57, v27
  s_add_u32 m0, s73, 17024
  s_add_u32 s55, s52, 262144
  buffer_load_dwordx4 v3, s[8:11], s55 offen lds
  v_sub_f32 v48, v48, v49
  v_sub_f32 v50, v50, v51
  v_sub_f32 v52, v52, v53
  v_sub_f32 v54, v54, v55
  v_cvt_pk_bf16_f32 v90, v48, v50
  v_cvt_pk_bf16_f32 v91, v52, v54
  s_add_u32 m0, s73, 21120
  s_add_u32 s55, s52, 786432
  buffer_load_dwordx4 v3, s[8:11], s55 offen lds
  v_lshlrev_b32 v48, 16, v44
  v_lshlrev_b32 v49, 16, v28
  v_and_b32 v50, s57, v44
  v_and_b32 v51, s57, v28
  v_lshlrev_b32 v52, 16, v45
  s_add_u32 m0, s73, 25216
  s_add_u32 s55, s52, 1310720
  buffer_load_dwordx4 v3, s[8:11], s55 offen lds
  v_lshlrev_b32 v53, 16, v29
  v_and_b32 v54, s57, v45
  v_and_b32 v55, s57, v29
  v_sub_f32 v48, v48, v49
  v_sub_f32 v50, v50, v51
  v_sub_f32 v52, v52, v53
  s_add_u32 m0, s73, 29312
  s_add_u32 s55, s52, 278528
  buffer_load_dwordx4 v3, s[8:11], s55 offen lds
  v_sub_f32 v54, v54, v55
  v_cvt_pk_bf16_f32 v92, v48, v50
  v_cvt_pk_bf16_f32 v93, v52, v54
  v_lshlrev_b32 v48, 16, v46
  v_lshlrev_b32 v49, 16, v30
  s_add_u32 m0, s73, 33408
  s_add_u32 s55, s52, 802816
  buffer_load_dwordx4 v3, s[8:11], s55 offen lds
  v_and_b32 v50, s57, v46
  v_and_b32 v51, s57, v30
  v_lshlrev_b32 v52, 16, v47
  v_lshlrev_b32 v53, 16, v31
  v_and_b32 v54, s57, v47
  v_and_b32 v55, s57, v31
  s_add_u32 m0, s73, 37504
  s_add_u32 s55, s52, 1327104
  buffer_load_dwordx4 v3, s[8:11], s55 offen lds
  v_sub_f32 v48, v48, v49
  v_sub_f32 v50, v50, v51
  v_sub_f32 v52, v52, v53
  v_sub_f32 v54, v54, v55
  v_cvt_pk_bf16_f32 v94, v48, v50
  v_cvt_pk_bf16_f32 v95, v52, v54
  s_waitcnt vmcnt(10)
  s_cmp_lg_u32 s60, 1
  s_cbranch_scc1 L_spin1_ok
  s_mov_b32 s56, 16384
L_spin1:
  v_cmp_eq_u64 vcc, s[62:63], v[56:57]
  s_cmp_eq_u64 vcc, -1
  s_cbranch_scc1 L_spin1_ok
  s_sub_u32 s56, s56, 1
  s_cbranch_scc1 L_spin1_ok
  buffer_load_dwordx2 v[56:57], v8, s[16:19], s67 offen sc0 sc1
  s_waitcnt vmcnt(0)
  s_branch L_spin1
L_spin1_ok:
  s_barrier
  s_setprio 3
  ds_write_b128 v4, v[80:83] offset:49792
  ds_write_b128 v4, v[84:87] offset:50848
  s_setprio 0
  s_add_u32 m0, s73, 66816
  s_add_u32 s55, s53, 1048576
  buffer_load_dwordx4 v3, s[16:19], s55 offen sc1 lds
  s_add_u32 m0, s73, 70912
  s_add_u32 s55, s53, 1179648
  buffer_load_dwordx4 v3, s[16:19], s55 offen sc1 lds
  s_add_u32 m0, s73, 75008
  s_add_u32 s55, s53, 1310720
  buffer_load_dwordx4 v3, s[16:19], s55 offen sc1 lds
  s_add_u32 m0, s73, 91392
  s_add_u32 s55, s53, 1441792
  buffer_load_dwordx4 v3, s[16:19], s55 offen sc1 lds
  s_add_u32 m0, s73, 79104
  s_add_u32 s55, s53, 1064960
  buffer_load_dwordx4 v3, s[16:19], s55 offen sc1 lds
  s_add_u32 m0, s73, 83200
  s_add_u32 s55, s53, 1196032
  buffer_load_dwordx4 v3, s[16:19], s55 offen sc1 lds
  s_add_u32 m0, s73, 87296
  s_add_u32 s55, s53, 1327104
  buffer_load_dwordx4 v3, s[16:19], s55 offen sc1 lds
  s_add_u32 m0, s73, 95488
  s_add_u32 s55, s53, 1458176
  buffer_load_dwordx4 v3, s[16:19], s55 offen sc1 lds
  s_add_u32 m0, s73, 141184
  s_add_u32 s55, s52, 1703936
  buffer_load_dwordx4 v3, s[8:11], s55 offen lds
  s_add_u32 m0, s73, 145280
  s_add_u32 s55, s52, 1720320
  buffer_load_dwordx4 v3, s[8:11], s55 offen lds
  ds_read_b128 v[16:19], v6 offset:0
  ds_read_b128 v[20:23], v6 offset:1056
  ds_read_b128 v[24:27], v6 offset:2112
  ds_read_b128 v[28:31], v6 offset:3168
  s_cmp_lt_u32 s60, 3
  s_cselect_b32 s56, s61, 1073741824
  s_lshl_b32 s55, s60, 7
  s_add_u32 s55, s55, s56
  s_add_u32 s55, s55, 128
  s_mov_b64 exec, 0xffff
  buffer_load_dword v66, v15, s[4:7], s55 offen
  s_mov_b64 exec, -1
  s_waitcnt vmcnt(11)
  ds_read_b128 v[32:35], v4 offset:0
  ds_read_b128 v[36:39], v4 offset:1056
  ds_read_b128 v[40:43], v4 offset:2112
  ds_read_b128 v[44:47], v4 offset:3168
  s_mov_b32 s53, s52
  s_waitcnt lgkmcnt(0)
  s_barrier
  s_setprio 3
  ds_write_b128 v4, v[88:91] offset:51904
  ds_write_b128 v4, v[92:95] offset:52960
  s_setprio 0
  s_cmp_lg_u32 s46, 0
  s_cbranch_scc1 L_nt4
  s_mov_b32 m0, 116480
  s_add_u32 s55, s51, 262656
  s_mov_b64 exec, 0xff
  buffer_load_dwordx4 v1, s[4:7], s55 offen lds
  s_mov_b64 exec, -1
  L_nt4:
  s_add_u32 m0, s74, 99584
  s_add_u32 s55, s51, 512
  buffer_load_dwordx4 v1, s[4:7], s55 offen lds
  v_lshlrev_b32 v48, 16, v32
  v_lshlrev_b32 v49, 16, v16
  v_and_b32 v50, s57, v32
  v_and_b32 v51, s57, v16
  v_lshlrev_b32 v52, 16, v33
  s_add_u32 m0, s74, 100640
  s_add_u32 s55, s51, 16896
  buffer_load_dwordx4 v1, s[4:7], s55 offen lds
  v_lshlrev_b32 v53, 16, v17
  v_and_b32 v54, s57, v33
  v_and_b32 v55, s57, v17
  v_sub_f32 v48, v48, v49
  v_sub_f32 v50, v50, v51
  v_sub_f32 v52, v52, v53
  s_add_u32 m0, s74, 101696
  s_add_u32 s55, s51, 33280
  buffer_load_dwordx4 v1, s[4:7], s55 offen lds
  v_sub_f32 v54, v54, v55
  v_cvt_pk_bf16_f32 v80, v48, v50
  v_cvt_pk_bf16_f32 v81, v52, v54
  v_lshlrev_b32 v48, 16, v34
  v_lshlrev_b32 v49, 16, v18
  s_add_u32 m0, s74, 102752
  s_add_u32 s55, s51, 49664
  buffer_load_dwordx4 v1, s[4:7], s55 offen lds
  v_and_b32 v50, s57, v34
  v_and_b32 v51, s57, v18
  v_lshlrev_b32 v52, 16, v35
  v_lshlrev_b32 v53, 16, v19
  v_and_b32 v54, s57, v35
  v_and_b32 v55, s57, v19
  s_add_u32 m0, s73, 116608
  s_add_u32 s55, s52, 131072
  buffer_load_dwordx4 v3, s[8:11], s55 offen lds
  v_sub_f32 v48, v48, v49
  v_sub_f32 v50, v50, v51
  v_sub_f32 v52, v52, v53
  v_sub_f32 v54, v54, v55
  v_cvt_pk_bf16_f32 v82, v48, v50
  v_cvt_pk_bf16_f32 v83, v52, v54
  s_add_u32 m0, s73, 120704
  s_add_u32 s55, s52, 655360
  buffer_load_dwordx4 v3, s[8:11], s55 offen lds
  v_lshlrev_b32 v48, 16, v36
  v_lshlrev_b32 v49, 16, v20
  v_and_b32 v50, s57, v36
  v_and_b32 v51, s57, v20
  v_lshlrev_b32 v52, 16, v37
  s_add_u32 m0, s73, 124800
  s_add_u32 s55, s52, 1179648
  buffer_load_dwordx4 v3, s[8:11], s55 offen lds
  v_lshlrev_b32 v53, 16, v21
  v_and_b32 v54, s57, v37
  v_and_b32 v55, s57, v21
  v_sub_f32 v48, v48, v49
  v_sub_f32 v50, v50, v51
  v_sub_f32 v52, v52, v53
  s_add_u32 m0, s73, 128896
  s_add_u32 s55, s52, 147456
  buffer_load_dwordx4 v3, s[8:11], s55 offen lds
  v_sub_f32 v54, v54, v55
  v_cvt_pk_bf16_f32 v84, v48, v50
  v_cvt_pk_bf16_f32 v85, v52, v54
  v_lshlrev_b32 v48, 16, v38
  v_lshlrev_b32 v49, 16, v22
  s_add_u32 m0, s73, 132992
  s_add_u32 s55, s52, 671744
  buffer_load_dwordx4 v3, s[8:11], s55 offen lds
  v_and_b32 v50, s57, v38
  v_and_b32 v51, s57, v22
  v_lshlrev_b32 v52, 16, v39
  v_lshlrev_b32 v53, 16, v23
  v_and_b32 v54, s57, v39
  v_and_b32 v55, s57, v23
  s_add_u32 m0, s73, 137088
  s_add_u32 s55, s52, 1196032
  buffer_load_dwordx4 v3, s[8:11], s55 offen lds
  v_sub_f32 v48, v48, v49
  v_sub_f32 v50, v50, v51
  v_sub_f32 v52, v52, v53
  v_sub_f32 v54, v54, v55
  v_cvt_pk_bf16_f32 v86, v48, v50
  v_cvt_pk_bf16_f32 v87, v52, v54
  s_waitcnt vmcnt(13) lgkmcnt(0)
  s_barrier
  s_add_u32 m0, s74, 0
  s_add_u32 s55, s51, 1536
  buffer_load_dwordx4 v1, s[4:7], s55 offen lds
  v_lshlrev_b32 v48, 16, v40
  v_lshlrev_b32 v49, 16, v24
  v_and_b32 v50, s57, v40
  v_and_b32 v51, s57, v24
  s_add_u32 m0, s74, 1056
  s_add_u32 s55, s51, 17920
  buffer_load_dwordx4 v1, s[4:7], s55 offen lds
  v_lshlrev_b32 v52, 16, v41
  v_lshlrev_b32 v53, 16, v25
  v_and_b32 v54, s57, v41
  v_and_b32 v55, s57, v25
  v_sub_f32 v48, v48, v49
  s_add_u32 m0, s74, 2112
  s_add_u32 s55, s51, 34304
  buffer_load_dwordx4 v1, s[4:7], s55 offen lds
  v_sub_f32 v50, v50, v51
  v_sub_f32 v52, v52, v53
  v_sub_f32 v54, v54, v55
  v_cvt_pk_bf16_f32 v88, v48, v50
  v_cvt_pk_bf16_f32 v89, v52, v54
  s_add_u32 m0, s74, 3168
  s_add_u32 s55, s51, 50688
  buffer_load_dwordx4 v1, s[4:7], s55 offen lds
  v_lshlrev_b32 v48, 16, v42
  v_lshlrev_b32 v49, 16, v26
  v_and_b32 v50, s57, v42
  v_and_b32 v51, s57, v26
  s_add_u32 m0, s73, 17024
  s_add_u32 s55, s52, 393216
  buffer_load_dwordx4 v3, s[8:11], s55 offen lds
  v_lshlrev_b32 v52, 16, v43
  v_lshlrev_b32 v53, 16, v27
  v_and_b32 v54, s57, v43
  v_and_b32 v55, s57, v27
  v_sub_f32 v48, v48, v49
  s_add_u32 m0, s73, 21120
  s_add_u32 s55, s52, 917504
  buffer_load_dwordx4 v3, s[8:11], s55 offen lds
  v_sub_f32 v50, v50, v51
  v_sub_f32 v52, v52, v53
  v_sub_f32 v54, v54, v55
  v_cvt_pk_bf16_f32 v90, v48, v50
  v_cvt_pk_bf16_f32 v91, v52, v54
  s_add_u32 m0, s73, 25216
  s_add_u32 s55, s52, 1441792
  buffer_load_dwordx4 v3, s[8:11], s55 offen lds
  v_lshlrev_b32 v48, 16, v44
  v_lshlrev_b32 v49, 16, v28
  v_and_b32 v50, s57, v44
  v_and_b32 v51, s57, v28
  s_add_u32 m0, s73, 29312
  s_add_u32 s55, s52, 409600
  buffer_load_dwordx4 v3, s[8:11], s55 offen lds
  v_lshlrev_b32 v52, 16, v45
  v_lshlrev_b32 v53, 16, v29
  v_and_b32 v54, s57, v45
  v_and_b32 v55, s57, v29
  v_sub_f32 v48, v48, v49
  s_add_u32 m0, s73, 33408
  s_add_u32 s55, s52, 933888
  buffer_load_dwordx4 v3, s[8:11], s55 offen lds
  v_sub_f32 v50, v50, v51
  v_sub_f32 v52, v52, v53
  v_sub_f32 v54, v54, v55
  v_cvt_pk_bf16_f32 v92, v48, v50
  v_cvt_pk_bf16_f32 v93, v52, v54
  s_add_u32 m0, s73, 37504
  s_add_u32 s55, s52, 1458176
  buffer_load_dwordx4 v3, s[8:11], s55 offen lds
  v_lshlrev_b32 v48, 16, v46
  v_lshlrev_b32 v49, 16, v30
  v_and_b32 v50, s57, v46
  v_and_b32 v51, s57, v30
  s_add_u32 m0, s73, 41600
  s_add_u32 s55, s50, 1835008
  buffer_load_dwordx4 v3, s[8:11], s55 offen lds
  v_lshlrev_b32 v52, 16, v47
  v_lshlrev_b32 v53, 16, v31
  v_and_b32 v54, s57, v47
  v_and_b32 v55, s57, v31
  v_sub_f32 v48, v48, v49
  s_add_u32 m0, s73, 45696
  s_add_u32 s55, s50, 1851392
  buffer_load_dwordx4 v3, s[8:11], s55 offen lds
  v_sub_f32 v50, v50, v51
  v_sub_f32 v52, v52, v53
  v_sub_f32 v54, v54, v55
  v_cvt_pk_bf16_f32 v94, v48, v50
  v_cvt_pk_bf16_f32 v95, v52, v54
  s_waitcnt vmcnt(12)
  s_cmp_eq_u32 s60, 2
  s_cbranch_scc1 L_wm0
L_wmret:
  s_barrier
  s_branch L_lloop
.p2align 6
L_wm0:
  s_branch L_wm1
L_cdone:
  s_waitcnt lgkmcnt(8)
  v_mfma_f32_16x16x32_bf16 v[80:83], v[156:159], v[112:115], v[80:83]
  ds_read_b64_tr_b16 v[216:217], v2 offset:12288
  v_mfma_f32_16x16x32_bf16 v[80:83], v[160:163], v[116:119], v[80:83]
  ds_read_b64_tr_b16 v[218:219], v2 offset:12800
  v_mfma_f32_16x16x32_bf16 v[84:87], v[156:159], v[116:119], v[84:87]
  ds_read_b128 v[172:175], v1 offset:64
  v_mfma_f32_16x16x32_bf16 v[84:87], v[160:163], v[120:123], v[84:87]
  ds_read_b64_tr_b16 v[220:221], v2 offset:16384
  v_mfma_f32_16x16x32_bf16 v[88:91], v[156:159], v[120:123], v[88:91]
  ds_read_b64_tr_b16 v[222:223], v2 offset:16896
  v_mfma_f32_16x16x32_bf16 v[88:91], v[160:163], v[124:127], v[88:91]
  ds_read_b128 v[176:179], v1 offset:192
  v_mfma_f32_16x16x32_bf16 v[92:95], v[156:159], v[124:127], v[92:95]
  ds_read_b128 v[180:183], v1 offset:320
  v_mfma_f32_16x16x32_bf16 v[92:95], v[160:163], v[128:131], v[92:95]
  ds_read_b128 v[184:187], v1 offset:448
  s_waitcnt lgkmcnt(12)
  v_mfma_f32_16x16x32_bf16 v[96:99], v[156:159], v[128:131], v[96:99]
  ds_read_b128 v[188:191], v1 offset:576
  v_mfma_f32_16x16x32_bf16 v[96:99], v[160:163], v[132:135], v[96:99]
  ds_read_b128 v[192:195], v1 offset:704
  v_mfma_f32_16x16x32_bf16 v[100:103], v[156:159], v[132:135], v[100:103]
  ds_read_b128 v[196:199], v1 offset:832
  v_mfma_f32_16x16x32_bf16 v[100:103], v[160:163], v[136:139], v[100:103]
  ds_read_b128 v[200:203], v1 offset:960
  v_mfma_f32_16x16x32_bf16 v[104:107], v[156:159], v[136:139], v[104:107]
  ds_read_b128 v[204:207], v1 offset:1120
  v_mfma_f32_16x16x32_bf16 v[104:107], v[160:163], v[140:143], v[104:107]
  ds_read_b64_tr_b16 v[224:225], v2 offset:20480
  v_mfma_f32_16x16x32_bf16 v[108:111], v[156:159], v[140:143], v[108:111]
  ds_read_b64_tr_b16 v[226:227], v2 offset:20992
  v_mfma_f32_16x16x32_bf16 v[108:111], v[160:163], v[144:147], v[108:111]
  ds_read_b64_tr_b16 v[228:229], v2 offset:28672
  v_mfma_f32_16x16x32_bf16 v[80:83], v[164:167], v[120:123], v[80:83]
  ds_read_b64_tr_b16 v[230:231], v2 offset:29184
  v_mfma_f32_16x16x32_bf16 v[80:83], v[168:171], v[124:127], v[80:83]
  ds_read_b128 v[208:211], v1 offset:1248
  v_mfma_f32_16x16x32_bf16 v[84:87], v[164:167], v[124:127], v[84:87]
  v_mfma_f32_16x16x32_bf16 v[84:87], v[168:171], v[128:131], v[84:87]
  ds_read_b128 v[212:215], v1 offset:1376
  v_mov_b32 v12, 157568
  ds_read_b64 v[238:239], v12
  v_mfma_f32_16x16x32_bf16 v[88:91], v[164:167], v[128:131], v[88:91]
  v_mov_b32_dpp v148, v116 row_shl:1 row_mask:0xf bank_mask:0xf bound_ctrl:0
  v_mfma_f32_16x16x32_bf16 v[88:91], v[168:171], v[132:135], v[88:91]
  v_mov_b32_dpp v149, v117 row_shl:1 row_mask:0xf bank_mask:0xf bound_ctrl:0
  v_mfma_f32_16x16x32_bf16 v[92:95], v[164:167], v[132:135], v[92:95]
  v_mov_b32_dpp v150, v118 row_shl:1 row_mask:0xf bank_mask:0xf bound_ctrl:0
  v_mfma_f32_16x16x32_bf16 v[92:95], v[168:171], v[136:139], v[92:95]
  v_mov_b32_dpp v151, v119 row_shl:1 row_mask:0xf bank_mask:0xf bound_ctrl:0
  v_mfma_f32_16x16x32_bf16 v[96:99], v[164:167], v[136:139], v[96:99]
  v_mov_b32_dpp v152, v120 row_shl:1 row_mask:0xf bank_mask:0xf bound_ctrl:0
  v_mfma_f32_16x16x32_bf16 v[96:99], v[168:171], v[140:143], v[96:99]
  v_mov_b32_dpp v153, v121 row_shl:1 row_mask:0xf bank_mask:0xf bound_ctrl:0
  v_mfma_f32_16x16x32_bf16 v[100:103], v[164:167], v[140:143], v[100:103]
  v_mov_b32_dpp v154, v122 row_shl:1 row_mask:0xf bank_mask:0xf bound_ctrl:0
  v_mfma_f32_16x16x32_bf16 v[100:103], v[168:171], v[144:147], v[100:103]
  v_mov_b32_dpp v155, v123 row_shl:1 row_mask:0xf bank_mask:0xf bound_ctrl:0
  v_mfma_f32_16x16x32_bf16 v[104:107], v[164:167], v[144:147], v[104:107]
  v_mov_b32_dpp v232, v16 row_shl:1 row_mask:0xf bank_mask:0xf bound_ctrl:0
  v_mfma_f32_16x16x32_bf16 v[104:107], v[168:171], v[148:151], v[104:107]
  v_mov_b32_dpp v233, v17 row_shl:1 row_mask:0xf bank_mask:0xf bound_ctrl:0
  v_mfma_f32_16x16x32_bf16 v[108:111], v[164:167], v[148:151], v[108:111]
  v_mov_b32_dpp v234, v18 row_shl:1 row_mask:0xf bank_mask:0xf bound_ctrl:0
  v_mfma_f32_16x16x32_bf16 v[108:111], v[168:171], v[152:155], v[108:111]
  v_mov_b32_dpp v235, v19 row_shl:1 row_mask:0xf bank_mask:0xf bound_ctrl:0
  s_waitcnt lgkmcnt(11)
  v_mfma_f32_16x16x32_bf16 v[80:83], v[216:219], v[172:175], v[80:83]
  v_mfma_f32_16x16x32_bf16 v[80:83], v[220:223], v[176:179], v[80:83]
  v_add_f32 v112, v16, v48
  v_add_f32 v113, v17, v49
  v_mfma_f32_16x16x32_bf16 v[84:87], v[216:219], v[176:179], v[84:87]
  v_add_f32 v114, v18, v50
  v_add_f32 v115, v19, v51
  v_mfma_f32_16x16x32_bf16 v[84:87], v[220:223], v[180:183], v[84:87]
  v_add_f32 v116, v20, v52
  v_mfma_f32_16x16x32_bf16 v[88:91], v[216:219], v[180:183], v[88:91]
  v_add_f32 v117, v21, v53
  v_add_f32 v118, v22, v54
  v_mfma_f32_16x16x32_bf16 v[88:91], v[220:223], v[184:187], v[88:91]
  v_add_f32 v119, v23, v55
  v_mfma_f32_16x16x32_bf16 v[92:95], v[216:219], v[184:187], v[92:95]
  v_add_f32 v120, v24, v56
  v_add_f32 v121, v25, v57
  v_mfma_f32_16x16x32_bf16 v[92:95], v[220:223], v[188:191], v[92:95]
  v_add_f32 v122, v26, v58
  s_waitcnt lgkmcnt(7)
  v_mfma_f32_16x16x32_bf16 v[96:99], v[216:219], v[188:191], v[96:99]
  v_add_f32 v123, v27, v59
  v_add_f32 v124, v28, v60
  v_mfma_f32_16x16x32_bf16 v[96:99], v[220:223], v[192:195], v[96:99]
  v_add_f32 v125, v29, v61
  v_mfma_f32_16x16x32_bf16 v[100:103], v[216:219], v[192:195], v[100:103]
  v_add_f32 v126, v30, v62
  v_add_f32 v127, v31, v63
  v_mfma_f32_16x16x32_bf16 v[100:103], v[220:223], v[196:199], v[100:103]
  v_add_f32 v128, v32, v64
  v_add_f32 v129, v33, v65
  v_mfma_f32_16x16x32_bf16 v[104:107], v[216:219], v[196:199], v[104:107]
  v_add_f32 v130, v34, v66
  v_mfma_f32_16x16x32_bf16 v[104:107], v[220:223], v[200:203], v[104:107]
  v_add_f32 v131, v35, v67
  v_add_f32 v132, v36, v68
  v_mfma_f32_16x16x32_bf16 v[108:111], v[216:219], v[200:203], v[108:111]
  v_add_f32 v133, v37, v69
  v_mfma_f32_16x16x32_bf16 v[108:111], v[220:223], v[204:207], v[108:111]
  v_add_f32 v134, v38, v70
  v_add_f32 v135, v39, v71
  s_waitcnt lgkmcnt(3)
  v_mfma_f32_16x16x32_bf16 v[80:83], v[224:227], v[180:183], v[80:83]
  v_add_f32 v136, v40, v72
  v_mfma_f32_16x16x32_bf16 v[80:83], v[228:231], v[184:187], v[80:83]
  v_add_f32 v137, v41, v73
  v_add_f32 v138, v42, v74
  v_mfma_f32_16x16x32_bf16 v[84:87], v[224:227], v[184:187], v[84:87]
  v_add_f32 v139, v43, v75
  v_mfma_f32_16x16x32_bf16 v[84:87], v[228:231], v[188:191], v[84:87]
  v_add_f32 v140, v44, v76
  v_add_f32 v141, v45, v77
  v_mfma_f32_16x16x32_bf16 v[88:91], v[224:227], v[188:191], v[88:91]
  v_add_f32 v142, v46, v78
  v_mfma_f32_16x16x32_bf16 v[88:91], v[228:231], v[192:195], v[88:91]
  v_add_f32 v143, v47, v79
  v_add_f32 v48, v48, v20
  v_mfma_f32_16x16x32_bf16 v[92:95], v[224:227], v[192:195], v[92:95]
  v_add_f32 v49, v49, v21
  v_add_f32 v50, v50, v22
  v_mfma_f32_16x16x32_bf16 v[92:95], v[228:231], v[196:199], v[92:95]
  v_add_f32 v51, v51, v23
  s_waitcnt lgkmcnt(1)
  v_mfma_f32_16x16x32_bf16 v[96:99], v[224:227], v[196:199], v[96:99]
  v_add_f32 v52, v52, v24
  v_add_f32 v53, v53, v25
  v_mfma_f32_16x16x32_bf16 v[96:99], v[228:231], v[200:203], v[96:99]
  v_add_f32 v54, v54, v26
  v_mfma_f32_16x16x32_bf16 v[100:103], v[224:227], v[200:203], v[100:103]
  v_add_f32 v55, v55, v27
  v_add_f32 v56, v56, v28
  v_mfma_f32_16x16x32_bf16 v[100:103], v[228:231], v[204:207], v[100:103]
  v_add_f32 v57, v57, v29
  v_mfma_f32_16x16x32_bf16 v[104:107], v[224:227], v[204:207], v[104:107]
  v_add_f32 v58, v58, v30
  v_add_f32 v59, v59, v31
  v_mfma_f32_16x16x32_bf16 v[104:107], v[228:231], v[208:211], v[104:107]
  v_add_f32 v60, v60, v32
  v_mfma_f32_16x16x32_bf16 v[108:111], v[224:227], v[208:211], v[108:111]
  v_add_f32 v61, v61, v33
  v_add_f32 v62, v62, v34
  v_mfma_f32_16x16x32_bf16 v[108:111], v[228:231], v[212:215], v[108:111]
  v_add_f32 v63, v63, v35
  v_pk_add_f32 v[64:65], v[64:65], v[36:37]
  v_pk_add_f32 v[66:67], v[66:67], v[38:39]
  v_pk_add_f32 v[68:69], v[68:69], v[40:41]
  v_pk_add_f32 v[70:71], v[70:71], v[42:43]
  v_pk_add_f32 v[72:73], v[72:73], v[44:45]
  v_pk_add_f32 v[74:75], v[74:75], v[46:47]
  v_pk_add_f32 v[76:77], v[76:77], v[232:233]
  v_pk_add_f32 v[78:79], v[78:79], v[234:235]
  s_nop 7
  s_setprio 0
  v_pk_add_f32 v[80:81], v[80:81], v[48:49]
  v_pk_add_f32 v[82:83], v[82:83], v[50:51]
  v_pk_add_f32 v[84:85], v[84:85], v[52:53]
  v_pk_add_f32 v[86:87], v[86:87], v[54:55]
  v_pk_add_f32 v[88:89], v[88:89], v[56:57]
  v_pk_add_f32 v[90:91], v[90:91], v[58:59]
  v_pk_add_f32 v[92:93], v[92:93], v[60:61]
  v_pk_add_f32 v[94:95], v[94:95], v[62:63]
  v_pk_add_f32 v[96:97], v[96:97], v[64:65]
  v_pk_add_f32 v[98:99], v[98:99], v[66:67]
  v_pk_add_f32 v[100:101], v[100:101], v[68:69]
  v_pk_add_f32 v[102:103], v[102:103], v[70:71]
  v_pk_add_f32 v[104:105], v[104:105], v[72:73]
  v_pk_add_f32 v[106:107], v[106:107], v[74:75]
  v_pk_add_f32 v[108:109], v[108:109], v[76:77]
  v_pk_add_f32 v[110:111], v[110:111], v[78:79]
  v_pk_add_f32 v[16:17], v[112:113], v[80:81]
  v_pk_mul_f32 v[20:21], v[112:113], v[112:113]
  v_pk_add_f32 v[18:19], v[114:115], v[82:83]
  v_pk_mul_f32 v[22:23], v[114:115], v[114:115]
  v_pk_fma_f32 v[20:21], v[80:81], v[80:81], v[20:21]
  v_pk_fma_f32 v[22:23], v[82:83], v[82:83], v[22:23]
  v_pk_add_f32 v[16:17], v[16:17], v[116:117]
  v_pk_fma_f32 v[20:21], v[116:117], v[116:117], v[20:21]
  v_pk_add_f32 v[18:19], v[18:19], v[118:119]
  v_pk_fma_f32 v[22:23], v[118:119], v[118:119], v[22:23]
  s_mov_b64 exec, s[64:65]
  v_pk_add_f32 v[16:17], v[16:17], v[84:85]
  v_pk_fma_f32 v[20:21], v[84:85], v[84:85], v[20:21]
  v_pk_add_f32 v[18:19], v[18:19], v[86:87]
  v_pk_fma_f32 v[22:23], v[86:87], v[86:87], v[22:23]
  v_pk_add_f32 v[16:17], v[16:17], v[120:121]
  v_pk_fma_f32 v[20:21], v[120:121], v[120:121], v[20:21]
  v_pk_add_f32 v[18:19], v[18:19], v[122:123]
  v_pk_fma_f32 v[22:23], v[122:123], v[122:123], v[22:23]
  v_pk_add_f32 v[16:17], v[16:17], v[88:89]
  v_pk_fma_f32 v[20:21], v[88:89], v[88:89], v[20:21]
  v_pk_add_f32 v[18:19], v[18:19], v[90:91]
  v_pk_fma_f32 v[22:23], v[90:91], v[90:91], v[22:23]
  v_pk_add_f32 v[16:17], v[16:17], v[124:125]
  v_pk_fma_f32 v[20:21], v[124:125], v[124:125], v[20:21]
  v_pk_add_f32 v[18:19], v[18:19], v[126:127]
  v_pk_fma_f32 v[22:23], v[126:127], v[126:127], v[22:23]
  v_pk_add_f32 v[16:17], v[16:17], v[92:93]
  v_pk_fma_f32 v[20:21], v[92:93], v[92:93], v[20:21]
  v_pk_add_f32 v[18:19], v[18:19], v[94:95]
  v_pk_fma_f32 v[22:23], v[94:95], v[94:95], v[22:23]
  v_pk_add_f32 v[16:17], v[16:17], v[128:129]
  v_pk_fma_f32 v[20:21], v[128:129], v[128:129], v[20:21]
  v_pk_add_f32 v[18:19], v[18:19], v[130:131]
  v_pk_fma_f32 v[22:23], v[130:131], v[130:131], v[22:23]
  v_pk_add_f32 v[16:17], v[16:17], v[96:97]
  v_pk_fma_f32 v[20:21], v[96:97], v[96:97], v[20:21]
  v_pk_add_f32 v[18:19], v[18:19], v[98:99]
  v_pk_fma_f32 v[22:23], v[98:99], v[98:99], v[22:23]
  s_mov_b32 exec_lo, 0x7fff7fff
  s_mov_b32 exec_hi, 0x7fff7fff
  v_pk_add_f32 v[16:17], v[16:17], v[132:133]
  v_pk_fma_f32 v[20:21], v[132:133], v[132:133], v[20:21]
  v_pk_add_f32 v[18:19], v[18:19], v[134:135]
  v_pk_fma_f32 v[22:23], v[134:135], v[134:135], v[22:23]
  v_pk_add_f32 v[16:17], v[16:17], v[100:101]
  v_pk_fma_f32 v[20:21], v[100:101], v[100:101], v[20:21]
  v_pk_add_f32 v[18:19], v[18:19], v[102:103]
  v_pk_fma_f32 v[22:23], v[102:103], v[102:103], v[22:23]
  v_pk_add_f32 v[16:17], v[16:17], v[136:137]
  v_pk_fma_f32 v[20:21], v[136:137], v[136:137], v[20:21]
  v_pk_add_f32 v[18:19], v[18:19], v[138:139]
  v_pk_fma_f32 v[22:23], v[138:139], v[138:139], v[22:23]
  v_pk_add_f32 v[16:17], v[16:17], v[104:105]
  v_pk_fma_f32 v[20:21], v[104:105], v[104:105], v[20:21]
  v_pk_add_f32 v[18:19], v[18:19], v[106:107]
  v_pk_fma_f32 v[22:23], v[106:107], v[106:107], v[22:23]
  v_pk_add_f32 v[16:17], v[16:17], v[140:141]
  v_pk_fma_f32 v[20:21], v[140:141], v[140:141], v[20:21]
  v_pk_add_f32 v[18:19], v[18:19], v[142:143]
  v_pk_fma_f32 v[22:23], v[142:143], v[142:143], v[22:23]
  v_pk_add_f32 v[16:17], v[16:17], v[108:109]
  v_pk_fma_f32 v[20:21], v[108:109], v[108:109], v[20:21]
  v_pk_add_f32 v[18:19], v[18:19], v[110:111]
  v_pk_fma_f32 v[22:23], v[110:111], v[110:111], v[22:23]
  s_mov_b64 exec, -1
  s_nop 1
  v_add_f32_dpp v24, v16, v16 row_ror:8 row_mask:0xf bank_mask:0xf
  v_add_f32_dpp v25, v17, v17 row_ror:8 row_mask:0xf bank_mask:0xf
  v_add_f32_dpp v28, v20, v20 row_ror:8 row_mask:0xf bank_mask:0xf
  v_add_f32_dpp v29, v21, v21 row_ror:8 row_mask:0xf bank_mask:0xf
  v_add_f32_dpp v24, v18, v18 row_ror:8 row_mask:0xf bank_mask:0xc
  v_add_f32_dpp v25, v19, v19 row_ror:8 row_mask:0xf bank_mask:0xc
  v_add_f32_dpp v28, v22, v22 row_ror:8 row_mask:0xf bank_mask:0xc
  v_add_f32_dpp v29, v23, v23 row_ror:8 row_mask:0xf bank_mask:0xc
  s_nop 0
  v_add_f32_dpp v236, v24, v24 row_half_mirror row_mask:0xf bank_mask:0xf
  v_add_f32_dpp v237, v28, v28 row_half_mirror row_mask:0xf bank_mask:0xf
  s_nop 0
  v_add_f32_dpp v236, v25, v25 row_half_mirror row_mask:0xf bank_mask:0xa
  v_add_f32_dpp v237, v29, v29 row_half_mirror row_mask:0xf bank_mask:0xa
  s_nop 0
  v_add_f32_dpp v236, v236, v236 quad_perm:[1,0,3,2] row_mask:0xf bank_mask:0xf
  v_add_f32_dpp v237, v237, v237 quad_perm:[1,0,3,2] row_mask:0xf bank_mask:0xf
  s_nop 0
  v_add_f32_dpp v236, v236, v236 quad_perm:[2,3,0,1] row_mask:0xf bank_mask:0xf
  v_add_f32_dpp v237, v237, v237 quad_perm:[2,3,0,1] row_mask:0xf bank_mask:0xf
  s_mov_b32 exec_lo, 0x11111111
  s_mov_b32 exec_hi, 0x11111111
  s_waitcnt lgkmcnt(0)
  buffer_store_dwordx4 v[236:239], v9, s[16:19], s66 offen sc0 sc1
  s_mov_b64 exec, -1
  ds_write_b128 v10, v[112:115] offset:0
  ds_write_b128 v10, v[80:83] offset:256
  ds_write_b128 v11, v[116:119] offset:512
  ds_write_b128 v11, v[84:87] offset:768
  ds_write_b128 v10, v[120:123] offset:1024
  ds_write_b128 v10, v[88:91] offset:1280
  ds_write_b128 v11, v[124:127] offset:1536
  ds_write_b128 v11, v[92:95] offset:1792
  ds_write_b128 v10, v[128:131] offset:2048
  ds_write_b128 v10, v[96:99] offset:2304
  ds_write_b128 v11, v[132:135] offset:2560
  ds_write_b128 v11, v[100:103] offset:2816
  ds_write_b128 v10, v[136:139] offset:3072
  ds_write_b128 v10, v[104:107] offset:3328
  ds_write_b128 v11, v[140:143] offset:3584
  ds_write_b128 v11, v[108:111] offset:3840
  s_waitcnt lgkmcnt(0)
  s_barrier
  ds_read_b128 v[112:115], v244 offset:0
  ds_read_b128 v[116:119], v245 offset:0
  ds_read_b128 v[120:123], v244 offset:2048
  ds_read_b128 v[124:127], v245 offset:2048
  ds_read_b128 v[128:131], v246 offset:4096
  ds_read_b128 v[132:135], v247 offset:4096
  ds_read_b128 v[136:139], v246 offset:6144
  ds_read_b128 v[140:143], v247 offset:6144
  s_branch L_final
.p2align 6
L_wm1:
  s_branch L_wmret
L_last:
  s_setprio 3
  ds_write_b128 v4, v[80:83] offset:49792
  ds_write_b128 v4, v[84:87] offset:50848
  s_setprio 0
  s_add_u32 m0, s73, 66816
  s_add_u32 s55, s53, 524288
  buffer_load_dwordx4 v3, s[16:19], s55 offen sc1 lds
  s_add_u32 m0, s73, 70912
  s_add_u32 s55, s53, 655360
  buffer_load_dwordx4 v3, s[16:19], s55 offen sc1 lds
  s_add_u32 m0, s73, 75008
  s_add_u32 s55, s53, 786432
  buffer_load_dwordx4 v3, s[16:19], s55 offen sc1 lds
  s_add_u32 m0, s73, 91392
  s_add_u32 s55, s53, 917504
  buffer_load_dwordx4 v3, s[16:19], s55 offen sc1 lds
  s_add_u32 m0, s73, 79104
  s_add_u32 s55, s53, 540672
  buffer_load_dwordx4 v3, s[16:19], s55 offen sc1 lds
  s_add_u32 m0, s73, 83200
  s_add_u32 s55, s53, 671744
  buffer_load_dwordx4 v3, s[16:19], s55 offen sc1 lds
  s_add_u32 m0, s73, 87296
  s_add_u32 s55, s53, 802816
  buffer_load_dwordx4 v3, s[16:19], s55 offen sc1 lds
  s_add_u32 m0, s73, 95488
  s_add_u32 s55, s53, 933888
  buffer_load_dwordx4 v3, s[16:19], s55 offen sc1 lds
  ds_read_b128 v[16:19], v6 offset:0
  ds_read_b128 v[20:23], v6 offset:1056
  ds_read_b128 v[24:27], v6 offset:2112
  ds_read_b128 v[28:31], v6 offset:3168
  s_mov_b32 s24, s36
  s_and_b32 s25, s37, 0xffff
  s_mov_b32 s26, 512
  s_mov_b32 s27, 0x20000
  s_mov_b32 s28, s38
  s_and_b32 s29, s39, 0xffff
  s_mov_b32 s30, 512
  s_mov_b32 s31, 0x20000
  s_waitcnt vmcnt(8)
  ds_read_b128 v[32:35], v4 offset:0
  ds_read_b128 v[36:39], v4 offset:1056
  ds_read_b128 v[40:43], v4 offset:2112
  ds_read_b128 v[44:47], v4 offset:3168
  s_waitcnt lgkmcnt(0)
  s_barrier
  s_setprio 3
  ds_write_b128 v4, v[88:91] offset:51904
  ds_write_b128 v4, v[92:95] offset:52960
  s_setprio 0
  s_add_u32 m0, s73, 116608
  s_add_u32 s55, s53, 1048576
  buffer_load_dwordx4 v3, s[16:19], s55 offen sc1 lds
  v_lshlrev_b32 v48, 16, v32
  v_lshlrev_b32 v49, 16, v16
  v_and_b32 v50, s57, v32
  v_and_b32 v51, s57, v16
  v_lshlrev_b32 v52, 16, v33
  v_lshlrev_b32 v53, 16, v17
  v_and_b32 v54, s57, v33
  v_and_b32 v55, s57, v17
  v_sub_f32 v48, v48, v49
  v_sub_f32 v50, v50, v51
  v_sub_f32 v52, v52, v53
  s_add_u32 m0, s73, 120704
  s_add_u32 s55, s53, 1179648
  buffer_load_dwordx4 v3, s[16:19], s55 offen sc1 lds
  v_sub_f32 v54, v54, v55
  v_cvt_pk_bf16_f32 v80, v48, v50
  v_cvt_pk_bf16_f32 v81, v52, v54
  v_lshlrev_b32 v48, 16, v34
  v_lshlrev_b32 v49, 16, v18
  v_and_b32 v50, s57, v34
  v_and_b32 v51, s57, v18
  v_lshlrev_b32 v52, 16, v35
  v_lshlrev_b32 v53, 16, v19
  v_and_b32 v54, s57, v35
  v_and_b32 v55, s57, v19
  s_add_u32 m0, s73, 124800
  s_add_u32 s55, s53, 1310720
  buffer_load_dwordx4 v3, s[16:19], s55 offen sc1 lds
  v_sub_f32 v48, v48, v49
  v_sub_f32 v50, v50, v51
  v_sub_f32 v52, v52, v53
  v_sub_f32 v54, v54, v55
  v_cvt_pk_bf16_f32 v82, v48, v50
  v_cvt_pk_bf16_f32 v83, v52, v54
  v_lshlrev_b32 v48, 16, v36
  v_lshlrev_b32 v49, 16, v20
  v_and_b32 v50, s57, v36
  v_and_b32 v51, s57, v20
  v_lshlrev_b32 v52, 16, v37
  s_add_u32 m0, s73, 149376
  s_add_u32 s55, s53, 1441792
  buffer_load_dwordx4 v3, s[16:19], s55 offen sc1 lds
  v_lshlrev_b32 v53, 16, v21
  v_and_b32 v54, s57, v37
  v_and_b32 v55, s57, v21
  v_sub_f32 v48, v48, v49
  v_sub_f32 v50, v50, v51
  v_sub_f32 v52, v52, v53
  v_sub_f32 v54, v54, v55
  v_cvt_pk_bf16_f32 v84, v48, v50
  v_cvt_pk_bf16_f32 v85, v52, v54
  v_lshlrev_b32 v48, 16, v38
  v_lshlrev_b32 v49, 16, v22
  s_add_u32 m0, s73, 128896
  s_add_u32 s55, s53, 1064960
  buffer_load_dwordx4 v3, s[16:19], s55 offen sc1 lds
  v_and_b32 v50, s57, v38
  v_and_b32 v51, s57, v22
  v_lshlrev_b32 v52, 16, v39
  v_lshlrev_b32 v53, 16, v23
  v_and_b32 v54, s57, v39
  v_and_b32 v55, s57, v23
  v_sub_f32 v48, v48, v49
  v_sub_f32 v50, v50, v51
  v_sub_f32 v52, v52, v53
  v_sub_f32 v54, v54, v55
  v_cvt_pk_bf16_f32 v86, v48, v50
  v_cvt_pk_bf16_f32 v87, v52, v54
  s_waitcnt lgkmcnt(0)
  s_add_u32 m0, s73, 132992
  s_add_u32 s55, s53, 1196032
  buffer_load_dwordx4 v3, s[16:19], s55 offen sc1 lds
  v_lshlrev_b32 v48, 16, v40
  v_lshlrev_b32 v49, 16, v24
  v_and_b32 v50, s57, v40
  v_and_b32 v51, s57, v24
  v_lshlrev_b32 v52, 16, v41
  v_lshlrev_b32 v53, 16, v25
  v_and_b32 v54, s57, v41
  v_and_b32 v55, s57, v25
  v_sub_f32 v48, v48, v49
  s_add_u32 m0, s73, 137088
  s_add_u32 s55, s53, 1327104
  buffer_load_dwordx4 v3, s[16:19], s55 offen sc1 lds
  v_sub_f32 v50, v50, v51
  v_sub_f32 v52, v52, v53
  v_sub_f32 v54, v54, v55
  v_cvt_pk_bf16_f32 v88, v48, v50
  v_cvt_pk_bf16_f32 v89, v52, v54
  v_lshlrev_b32 v48, 16, v42
  v_lshlrev_b32 v49, 16, v26
  v_and_b32 v50, s57, v42
  v_and_b32 v51, s57, v26
  s_add_u32 m0, s73, 145280
  s_add_u32 s55, s53, 1458176
  buffer_load_dwordx4 v3, s[16:19], s55 offen sc1 lds
  v_lshlrev_b32 v52, 16, v43
  v_lshlrev_b32 v53, 16, v27
  v_and_b32 v54, s57, v43
  v_and_b32 v55, s57, v27
  v_sub_f32 v48, v48, v49
  v_sub_f32 v50, v50, v51
  v_sub_f32 v52, v52, v53
  v_sub_f32 v54, v54, v55
  v_cvt_pk_bf16_f32 v90, v48, v50
  v_cvt_pk_bf16_f32 v91, v52, v54
  s_waitcnt vmcnt(8)
  s_barrier
  v_lshlrev_b32 v48, 16, v44
  v_lshlrev_b32 v49, 16, v28
  v_and_b32 v50, s57, v44
  v_and_b32 v51, s57, v28
  v_lshlrev_b32 v52, 16, v45
  v_lshlrev_b32 v53, 16, v29
  v_and_b32 v54, s57, v45
  v_and_b32 v55, s57, v29
  v_sub_f32 v48, v48, v49
  v_sub_f32 v50, v50, v51
  v_sub_f32 v52, v52, v53
  v_sub_f32 v54, v54, v55
  v_cvt_pk_bf16_f32 v92, v48, v50
  v_cvt_pk_bf16_f32 v93, v52, v54
  v_lshlrev_b32 v48, 16, v46
  v_lshlrev_b32 v49, 16, v30
  v_and_b32 v50, s57, v46
  v_and_b32 v51, s57, v30
  v_lshlrev_b32 v52, 16, v47
  v_lshlrev_b32 v53, 16, v31
  v_and_b32 v54, s57, v47
  v_and_b32 v55, s57, v31
  v_sub_f32 v48, v48, v49
  v_sub_f32 v50, v50, v51
  v_sub_f32 v52, v52, v53
  v_sub_f32 v54, v54, v55
  v_cvt_pk_bf16_f32 v94, v48, v50
  v_cvt_pk_bf16_f32 v95, v52, v54
  ds_write_b128 v5, v[80:83] offset:0
  ds_write_b128 v5, v[84:87] offset:1056
  ds_write_b128 v5, v[88:91] offset:2112
  ds_write_b128 v5, v[92:95] offset:3168
  v_and_b32 v10, 15, v0
  s_lshl_b32 s55, s48, 2
  s_add_u32 s55, s55, s46
  s_lshl_b32 s55, s55, 5
  v_lshlrev_b32 v14, 1, v10
  buffer_load_ushort v68, v14, s[24:27], s55 offen
  buffer_load_ushort v69, v14, s[28:31], s55 offen
  s_waitcnt vmcnt(2) lgkmcnt(0)
  s_barrier
  v_lshrrev_b32 v11, 4, v0
  v_lshlrev_b32 v12, 4, v10
  v_lshl_add_u32 v12, v11, 10, v12
  s_lshl_b32 s55, s46, 6
  s_add_u32 s55, s55, 157632
  v_lshl_add_u32 v10, v10, 2, s55
  s_add_u32 s46, s46, 4
  v_lshrrev_b32 v248, 3, v0
  v_and_b32 v250, 7, v0
  s_lshl_b32 s55, s46, 5
  v_add_u32 v248, s55, v248
  v_bfe_u32 v244, v0, 4, 1
  v_lshl_or_b32 v244, v244, 3, v250
  s_lshl_b32 s55, s46, 1
  s_and_b32 s55, s55, 7
  v_xor_b32 v244, s55, v244
  v_lshlrev_b32 v244, 4, v244
  v_lshl_add_u32 v244, v248, 8, v244
  v_xor_b32 v245, 0x80, v244
  v_xor_b32 v246, 0x10, v244
  v_xor_b32 v247, 0x90, v244
  v_lshlrev_b32 v248, 9, v248
  v_lshl_add_u32 v248, v250, 4, v248
  s_lshl_b32 s55, s48, 7
  v_add_u32 v248, s55, v248
  v_add_u32 v249, 0x2000, v248
  v_lshlrev_b32 v250, 5, v250
  v_add_u32 v250, 157632, v250
  s_waitcnt vmcnt(0)
  v_lshlrev_b32 v68, 16, v68
  v_lshlrev_b32 v69, 16, v69
  v_mul_f32 v68, 0xbeeff558, v68
  v_mul_f32 v69, 0xbeeff558, v69
  s_barrier
  s_mov_b32 s56, 16384
  ds_read_b128 v[112:115], v244 offset:0
  ds_read_b128 v[116:119], v245 offset:0
  ds_read_b128 v[120:123], v244 offset:2048
  ds_read_b128 v[124:127], v245 offset:2048
  ds_read_b128 v[128:131], v246 offset:4096
  ds_read_b128 v[132:135], v247 offset:4096
  ds_read_b128 v[136:139], v246 offset:6144
  ds_read_b128 v[140:143], v247 offset:6144
L_poll:
  buffer_load_dwordx4 v[16:19], v12, s[16:19], s66 offen sc0 sc1
  s_add_u32 s55, s66, 4096
  buffer_load_dwordx4 v[20:23], v12, s[16:19], s55 offen sc0 sc1
  s_add_u32 s55, s66, 8192
  buffer_load_dwordx4 v[24:27], v12, s[16:19], s55 offen sc0 sc1
  s_add_u32 s55, s66, 12288
  buffer_load_dwordx4 v[28:31], v12, s[16:19], s55 offen sc0 sc1
  s_add_u32 s55, s66, 16384
  buffer_load_dwordx4 v[32:35], v12, s[16:19], s55 offen sc0 sc1
  s_add_u32 s55, s66, 20480
  buffer_load_dwordx4 v[36:39], v12, s[16:19], s55 offen sc0 sc1
  s_add_u32 s55, s66, 24576
  buffer_load_dwordx4 v[40:43], v12, s[16:19], s55 offen sc0 sc1
  s_add_u32 s55, s66, 28672
  buffer_load_dwordx4 v[44:47], v12, s[16:19], s55 offen sc0 sc1
  s_mov_b64 s[58:59], -1
  s_waitcnt vmcnt(7)
  v_cmp_eq_u64 vcc, s[62:63], v[18:19]
  s_and_b64 s[58:59], s[58:59], vcc
  s_waitcnt vmcnt(6)
  v_cmp_eq_u64 vcc, s[62:63], v[22:23]
  s_and_b64 s[58:59], s[58:59], vcc
  s_waitcnt vmcnt(5)
  v_cmp_eq_u64 vcc, s[62:63], v[26:27]
  s_and_b64 s[58:59], s[58:59], vcc
  s_waitcnt vmcnt(4)
  v_cmp_eq_u64 vcc, s[62:63], v[30:31]
  s_and_b64 s[58:59], s[58:59], vcc
  s_waitcnt vmcnt(3)
  v_cmp_eq_u64 vcc, s[62:63], v[34:35]
  s_and_b64 s[58:59], s[58:59], vcc
  s_waitcnt vmcnt(2)
  v_cmp_eq_u64 vcc, s[62:63], v[38:39]
  s_and_b64 s[58:59], s[58:59], vcc
  s_waitcnt vmcnt(1)
  v_cmp_eq_u64 vcc, s[62:63], v[42:43]
  s_and_b64 s[58:59], s[58:59], vcc
  s_waitcnt vmcnt(0)
  v_cmp_eq_u64 vcc, s[62:63], v[46:47]
  s_and_b64 s[58:59], s[58:59], vcc
  s_sub_u32 s56, s56, 1
  s_cbranch_scc1 L_poll_ok
  s_cmp_eq_u64 s[58:59], -1
  s_cbranch_scc0 L_poll
L_poll_ok:
  v_pk_add_f32 v[16:17], v[16:17], v[32:33]
  v_pk_add_f32 v[20:21], v[20:21], v[36:37]
  v_pk_add_f32 v[24:25], v[24:25], v[40:41]
  v_pk_add_f32 v[28:29], v[28:29], v[44:45]
  v_pk_add_f32 v[16:17], v[16:17], v[24:25]
  v_pk_add_f32 v[20:21], v[20:21], v[28:29]
  v_pk_add_f32 v[16:17], v[16:17], v[20:21]
  v_mov_b32 v18, v16
  v_mov_b32 v19, v17
  s_nop 1
  v_permlane32_swap_b32 v16, v18
  v_permlane32_swap_b32 v17, v19
  s_nop 1
  v_pk_add_f32 v[16:17], v[16:17], v[18:19]
  v_mov_b32 v18, v16
  v_mov_b32 v19, v17
  s_nop 1
  v_permlane16_swap_b32 v16, v18
  v_permlane16_swap_b32 v17, v19
  s_nop 1
  v_pk_add_f32 v[16:17], v[16:17], v[18:19]
  v_mul_f32 v16, 0x39032fd1, v16
  v_mul_f32 v17, 0x39032fd1, v17
  v_fma_f32 v17, -v16, v16, v17
  v_max_f32 v17, 0, v17
  v_add_f32 v17, 0x3727c5ac, v17
  v_rsq_f32 v17, v17
  s_nop 0
  v_mul_f32 v17, v17, v68
  ds_write_b32 v10, v17
  v_fma_f32 v16, -v16, v17, v69
  ds_write_b32 v10, v16 offset:256
L_final:
  s_mov_b32 s70, 0xbeeff558
  s_mov_b32 s71, 0xbeeff558
  s_mov_b32 s72, 4096
  v_mov_b32 v56, 0x409d30fc
  v_mov_b32 v57, 0x409d30fc
  s_waitcnt lgkmcnt(0)
  s_barrier
  ds_read_b128 v[16:19], v250
  ds_read_b128 v[24:27], v250 offset:256
  ds_read_b128 v[20:23], v250 offset:16
  ds_read_b128 v[28:31], v250 offset:272
  s_waitcnt lgkmcnt(2)
  v_pk_fma_f32 v[112:113], v[112:113], v[16:17], v[24:25]
  v_pk_fma_f32 v[114:115], v[114:115], v[18:19], v[26:27]
  s_waitcnt lgkmcnt(0)
  v_pk_fma_f32 v[116:117], v[116:117], v[20:21], v[28:29]
  v_pk_fma_f32 v[118:119], v[118:119], v[22:23], v[30:31]
  v_pk_fma_f32 v[40:41], v[112:113], v[112:113], v[56:57]
  v_pk_fma_f32 v[42:43], v[114:115], v[114:115], v[56:57]
  v_pk_fma_f32 v[44:45], v[116:117], v[116:117], v[56:57]
  v_pk_fma_f32 v[46:47], v[118:119], v[118:119], v[56:57]
  v_pk_mul_f32 v[40:41], v[40:41], v[112:113]
  v_pk_mul_f32 v[42:43], v[42:43], v[114:115]
  v_pk_mul_f32 v[44:45], v[44:45], v[116:117]
  v_pk_mul_f32 v[46:47], v[46:47], v[118:119]
  v_exp_f32 v40, v40
  v_exp_f32 v41, v41
  v_exp_f32 v42, v42
  v_exp_f32 v43, v43
  v_exp_f32 v44, v44
  v_exp_f32 v45, v45
  v_exp_f32 v46, v46
  v_exp_f32 v47, v47
  v_pk_fma_f32 v[40:41], v[40:41], s[70:71], s[70:71]
  v_pk_fma_f32 v[42:43], v[42:43], s[70:71], s[70:71]
  v_pk_fma_f32 v[44:45], v[44:45], s[70:71], s[70:71]
  v_pk_fma_f32 v[46:47], v[46:47], s[70:71], s[70:71]
  v_rcp_f32 v40, v40
  v_rcp_f32 v41, v41
  v_rcp_f32 v42, v42
  v_rcp_f32 v43, v43
  v_rcp_f32 v44, v44
  v_rcp_f32 v45, v45
  v_rcp_f32 v46, v46
  v_rcp_f32 v47, v47
  v_pk_mul_f32 v[112:113], v[112:113], v[40:41]
  v_pk_mul_f32 v[114:115], v[114:115], v[42:43]
  v_pk_mul_f32 v[116:117], v[116:117], v[44:45]
  v_pk_mul_f32 v[118:119], v[118:119], v[46:47]
  v_cvt_pk_bf16_f32 v32, v112, v113
  v_cvt_pk_bf16_f32 v33, v114, v115
  v_cvt_pk_bf16_f32 v34, v116, v117
  v_cvt_pk_bf16_f32 v35, v118, v119
  buffer_store_dwordx4 v[32:35], v248, s[12:15], 0 offen sc1
  v_pk_fma_f32 v[120:121], v[120:121], v[16:17], v[24:25]
  v_pk_fma_f32 v[122:123], v[122:123], v[18:19], v[26:27]
  v_pk_fma_f32 v[124:125], v[124:125], v[20:21], v[28:29]
  v_pk_fma_f32 v[126:127], v[126:127], v[22:23], v[30:31]
  v_pk_fma_f32 v[40:41], v[120:121], v[120:121], v[56:57]
  v_pk_fma_f32 v[42:43], v[122:123], v[122:123], v[56:57]
  v_pk_fma_f32 v[44:45], v[124:125], v[124:125], v[56:57]
  v_pk_fma_f32 v[46:47], v[126:127], v[126:127], v[56:57]
  v_pk_mul_f32 v[40:41], v[40:41], v[120:121]
  v_pk_mul_f32 v[42:43], v[42:43], v[122:123]
  v_pk_mul_f32 v[44:45], v[44:45], v[124:125]
  v_pk_mul_f32 v[46:47], v[46:47], v[126:127]
  v_exp_f32 v40, v40
  v_exp_f32 v41, v41
  v_exp_f32 v42, v42
  v_exp_f32 v43, v43
  v_exp_f32 v44, v44
  v_exp_f32 v45, v45
  v_exp_f32 v46, v46
  v_exp_f32 v47, v47
  v_pk_fma_f32 v[40:41], v[40:41], s[70:71], s[70:71]
  v_pk_fma_f32 v[42:43], v[42:43], s[70:71], s[70:71]
  v_pk_fma_f32 v[44:45], v[44:45], s[70:71], s[70:71]
  v_pk_fma_f32 v[46:47], v[46:47], s[70:71], s[70:71]
  v_rcp_f32 v40, v40
  v_rcp_f32 v41, v41
  v_rcp_f32 v42, v42
  v_rcp_f32 v43, v43
  v_rcp_f32 v44, v44
  v_rcp_f32 v45, v45
  v_rcp_f32 v46, v46
  v_rcp_f32 v47, v47
  v_pk_mul_f32 v[120:121], v[120:121], v[40:41]
  v_pk_mul_f32 v[122:123], v[122:123], v[42:43]
  v_pk_mul_f32 v[124:125], v[124:125], v[44:45]
  v_pk_mul_f32 v[126:127], v[126:127], v[46:47]
  v_cvt_pk_bf16_f32 v36, v120, v121
  v_cvt_pk_bf16_f32 v37, v122, v123
  v_cvt_pk_bf16_f32 v38, v124, v125
  v_cvt_pk_bf16_f32 v39, v126, v127
  buffer_store_dwordx4 v[36:39], v248, s[12:15], s72 offen sc1
  v_pk_fma_f32 v[128:129], v[128:129], v[16:17], v[24:25]
  v_pk_fma_f32 v[130:131], v[130:131], v[18:19], v[26:27]
  v_pk_fma_f32 v[132:133], v[132:133], v[20:21], v[28:29]
  v_pk_fma_f32 v[134:135], v[134:135], v[22:23], v[30:31]
  v_pk_fma_f32 v[40:41], v[128:129], v[128:129], v[56:57]
  v_pk_fma_f32 v[42:43], v[130:131], v[130:131], v[56:57]
  v_pk_fma_f32 v[44:45], v[132:133], v[132:133], v[56:57]
  v_pk_fma_f32 v[46:47], v[134:135], v[134:135], v[56:57]
  v_pk_mul_f32 v[40:41], v[40:41], v[128:129]
  v_pk_mul_f32 v[42:43], v[42:43], v[130:131]
  v_pk_mul_f32 v[44:45], v[44:45], v[132:133]
  v_pk_mul_f32 v[46:47], v[46:47], v[134:135]
  v_exp_f32 v40, v40
  v_exp_f32 v41, v41
  v_exp_f32 v42, v42
  v_exp_f32 v43, v43
  v_exp_f32 v44, v44
  v_exp_f32 v45, v45
  v_exp_f32 v46, v46
  v_exp_f32 v47, v47
  v_pk_fma_f32 v[40:41], v[40:41], s[70:71], s[70:71]
  v_pk_fma_f32 v[42:43], v[42:43], s[70:71], s[70:71]
  v_pk_fma_f32 v[44:45], v[44:45], s[70:71], s[70:71]
  v_pk_fma_f32 v[46:47], v[46:47], s[70:71], s[70:71]
  v_rcp_f32 v40, v40
  v_rcp_f32 v41, v41
  v_rcp_f32 v42, v42
  v_rcp_f32 v43, v43
  v_rcp_f32 v44, v44
  v_rcp_f32 v45, v45
  v_rcp_f32 v46, v46
  v_rcp_f32 v47, v47
  v_pk_mul_f32 v[128:129], v[128:129], v[40:41]
  v_pk_mul_f32 v[130:131], v[130:131], v[42:43]
  v_pk_mul_f32 v[132:133], v[132:133], v[44:45]
  v_pk_mul_f32 v[134:135], v[134:135], v[46:47]
  v_cvt_pk_bf16_f32 v32, v128, v129
  v_cvt_pk_bf16_f32 v33, v130, v131
  v_cvt_pk_bf16_f32 v34, v132, v133
  v_cvt_pk_bf16_f32 v35, v134, v135
  buffer_store_dwordx4 v[32:35], v249, s[12:15], 0 offen sc1
  v_pk_fma_f32 v[136:137], v[136:137], v[16:17], v[24:25]
  v_pk_fma_f32 v[138:139], v[138:139], v[18:19], v[26:27]
  v_pk_fma_f32 v[140:141], v[140:141], v[20:21], v[28:29]
  v_pk_fma_f32 v[142:143], v[142:143], v[22:23], v[30:31]
  v_pk_fma_f32 v[40:41], v[136:137], v[136:137], v[56:57]
  v_pk_fma_f32 v[42:43], v[138:139], v[138:139], v[56:57]
  v_pk_fma_f32 v[44:45], v[140:141], v[140:141], v[56:57]
  v_pk_fma_f32 v[46:47], v[142:143], v[142:143], v[56:57]
  v_pk_mul_f32 v[40:41], v[40:41], v[136:137]
  v_pk_mul_f32 v[42:43], v[42:43], v[138:139]
  v_pk_mul_f32 v[44:45], v[44:45], v[140:141]
  v_pk_mul_f32 v[46:47], v[46:47], v[142:143]
  v_exp_f32 v40, v40
  v_exp_f32 v41, v41
  v_exp_f32 v42, v42
  v_exp_f32 v43, v43
  v_exp_f32 v44, v44
  v_exp_f32 v45, v45
  v_exp_f32 v46, v46
  v_exp_f32 v47, v47
  v_pk_fma_f32 v[40:41], v[40:41], s[70:71], s[70:71]
  v_pk_fma_f32 v[42:43], v[42:43], s[70:71], s[70:71]
  v_pk_fma_f32 v[44:45], v[44:45], s[70:71], s[70:71]
  v_pk_fma_f32 v[46:47], v[46:47], s[70:71], s[70:71]
  v_rcp_f32 v40, v40
  v_rcp_f32 v41, v41
  v_rcp_f32 v42, v42
  v_rcp_f32 v43, v43
  v_rcp_f32 v44, v44
  v_rcp_f32 v45, v45
  v_rcp_f32 v46, v46
  v_rcp_f32 v47, v47
  v_pk_mul_f32 v[136:137], v[136:137], v[40:41]
  v_pk_mul_f32 v[138:139], v[138:139], v[42:43]
  v_pk_mul_f32 v[140:141], v[140:141], v[44:45]
  v_pk_mul_f32 v[142:143], v[142:143], v[46:47]
  v_cvt_pk_bf16_f32 v36, v136, v137
  v_cvt_pk_bf16_f32 v37, v138, v139
  v_cvt_pk_bf16_f32 v38, v140, v141
  v_cvt_pk_bf16_f32 v39, v142, v143
  buffer_store_dwordx4 v[36:39], v249, s[12:15], s72 offen sc1
L_end:
  s_endpgm
.p2align 8
.fill 1024, 4, 0xbf810000
.section .rodata,"a"
.p2align 6
.amdhsa_kernel standalone__self_sup_conv_stem_hubert__speech_kernel
  .amdhsa_next_free_vgpr 256
  .amdhsa_next_free_sgpr 102
  .amdhsa_accum_offset 256
  .amdhsa_group_segment_fixed_size 0
  .amdhsa_kernarg_size 64
  .amdhsa_user_sgpr_count 2
  .amdhsa_user_sgpr_kernarg_segment_ptr 1
  .amdhsa_system_sgpr_workgroup_id_x 1
.end_amdhsa_kernel
```
